```python
import torch

def _softmax(x, axis=-1):
    return torch.softmax(x, dim=axis)
def _gelu(x):
    return torch.nn.functional.gelu(x, approximate="tanh")
def _silu(x):
    return torch.nn.functional.silu(x)
def _sigmoid(x):
    return torch.sigmoid(x)
def _layernorm(x, axis=-1, eps=1e-5):
    m = x.mean(dim=axis, keepdim=True)
    v = x.var(dim=axis, keepdim=True, unbiased=False)
    return (x - m) / torch.sqrt(v + eps)
def _scatter_add(tgt, idx, src, axis=0):
    return tgt.clone().index_add_(axis, idx, src)
def _segment_sum(src, seg, n):
    out = torch.zeros((n,) + src.shape[1:], dtype=src.dtype)
    return out.index_add_(0, seg, src)
def _pad(x, pw):
    flat = tuple(v for pair in reversed(pw) for v in pair)
    return torch.nn.functional.pad(x, flat)

kernel_name = 'parallel_sum__softmax_full_mha__mixer_channel_mlp__prompt'

def setup_inputs():

    _w = (lambda a: (lambda t: t.to(torch.bfloat16) if t.is_floating_point() else t)(torch.as_tensor(a)))
    def _A_setup():
        B, S, D = 1, 2048, 640
        return {
            "x": _w((lambda *s: torch.randn(*s, dtype=torch.bfloat16) * 0.05)(B, S, D)),
            "wqkv": _w((lambda *s: torch.randn(*s, dtype=torch.bfloat16) * 0.05)(D, 3 * D)),
            "wo": _w((lambda *s: torch.randn(*s, dtype=torch.bfloat16) * 0.05)(D, D)),
        }
    _A_in = _A_setup()

    def _B_setup():
        B, S, D, F = 1, 2048, 640, 1536
        return {
            "x": _w((lambda *s: torch.randn(*s, dtype=torch.bfloat16) * 0.05)(B, S, D)),
            "w1": _w((lambda *s: torch.randn(*s, dtype=torch.bfloat16) * 3.2)(D, F) * (D ** -0.5)),
            "b1": _w((lambda *s: torch.randn(*s, dtype=torch.bfloat16) * 1.6)(F)),
            "w2": _w((lambda *s: torch.randn(*s, dtype=torch.bfloat16) * 0.1)(F, D) * (F ** -0.5)),
            "b2": _w((lambda *s: torch.randn(*s, dtype=torch.bfloat16) * 0.2)(D)),
        }
    _B_in = _B_setup()

    return {
        "A_x": _A_in["x"],
        "A_wqkv": _A_in["wqkv"],
        "A_wo": _A_in["wo"],
        "B_x": _B_in["x"],
        "B_w1": _B_in["w1"],
        "B_b1": _B_in["b1"],
        "B_w2": _B_in["w2"],
        "B_b2": _B_in["b2"],
    }

def reference(A_x, A_wqkv, A_wo, B_x, B_w1, B_b1, B_w2, B_b2):
    def _A_ref(x, wqkv, wo):
        B, S, D = x.shape
        H = 32; Dh = D // H
        qkv = (lambda x, *d: x.permute(*d))((x @ wqkv).reshape(B, S, 3, H, Dh), 2, 0, 3, 1, 4)
        q, k, v = qkv[0], qkv[1], qkv[2]
        scale = Dh ** -0.5
        scores = torch.einsum("bhqd,bhkd->bhqk", q, k) * scale
        p = _softmax(scores, axis=-1)
        o = torch.einsum("bhqk,bhkd->bhqd", p, v)
        return (lambda x, *d: x.permute(*d))(o, 0, 2, 1, 3).reshape(B, S, D) @ wo

    def _B_ref(x, w1, b1, w2, b2):
        y = _layernorm(x, axis=-1)
        h = _gelu(torch.einsum("bsd,df->bsf", y, w1) + b1)
        return torch.einsum("bsf,fd->bsd", h, w2) + b2

    x = A_x
    xn = _layernorm(x, axis=-1)
    return x + _A_ref(xn, A_wqkv, A_wo) + _B_ref(xn, B_w1, B_b1, B_w2, B_b2)
```

```asm
; @launch kernel=k1_kernel grid=(256,1,1) block=(512,1,1) lds=153600
; @launch kernel=k2_kernel grid=(256,1,1) block=(512,1,1) lds=147520
.amdgcn_target "amdgcn-amd-amdhsa--gfx950"
.text
.globl k1_kernel
.p2align 8
.type k1_kernel,@function
k1_kernel:
    s_cmp_ge_u32 s2, 256
    s_cbranch_scc1 k1_done
    s_load_dwordx4 s[4:7], s[0:1], 0
    s_load_dwordx4 s[48:51], s[0:1], 32
    s_load_dwordx2 s[52:53], s[0:1], 16
    s_load_dwordx2 s[54:55], s[0:1], 48
    s_load_dwordx4 s[56:59], s[0:1], 72
    v_lshrrev_b32 v1, 6, v0
    s_and_b32 s32, s2, 7
    v_readfirstlane_b32 s25, v1
    v_and_b32 v1, 63, v0
    s_lshr_b32 s33, s2, 3
    s_lshr_b32 s34, s32, 2
    s_and_b32 s35, s32, 3
    s_mov_b32 s45, 1.0
    s_cmp_ge_u32 s33, 15
    s_cbranch_scc1 k1_dh
    s_mul_i32 s36, s35, 15
    s_add_u32 s36, s36, s33
    s_lshr_b32 s75, s36, 2
    s_and_b32 s38, s36, 3
    s_lshl_b32 s39, s34, 2
    s_add_u32 s38, s38, s39
    s_lshl_b32 s30, s38, 8
    s_lshl_b32 s31, s75, 7
    s_mov_b32 s29, s31
    s_movk_i32 s27, 256
    s_movk_i32 s26, 128
    s_cmp_lt_u32 s75, 5
    s_cselect_b32 s45, 0x3ea52b5c, s45
    s_cmp_ge_u32 s75, 10
    s_cselect_b32 s28, 1, 0
    s_branch k1_dd
k1_dh:
    s_sub_u32 s36, s33, 15
    s_lshr_b32 s37, s36, 3
    s_lshl_b32 s38, s35, 1
    s_add_u32 s37, s37, s38
    s_and_b32 s38, s36, 7
    s_lshl_b32 s39, s34, 3
    s_add_u32 s38, s38, s39
    s_lshl_b32 s30, s38, 7
    s_mul_i32 s31, s37, 192
    s_add_u32 s29, s31, 1920
    s_movk_i32 s27, 128
    s_movk_i32 s26, 192
    s_cmp_ge_u32 s33, 31
    s_cselect_b32 s28, 3, 2
k1_dd:
    s_cmp_lt_u32 s25, 6
    s_cbranch_scc1 k1_other
    s_sub_u32 s25, s25, 6
    s_cmp_eq_u32 s28, 3
    s_cbranch_scc0 k1_ld0
    s_waitcnt lgkmcnt(0)
    s_branch k1_ld_pack
k1_ld0:
    v_lshrrev_b32 v2, 3, v1
    v_and_b32 v3, 7, v1
    v_lshrrev_b32 v4, 4, v1
    s_lshr_b32 s40, s27, 1
    s_mul_i32 s40, s40, s25
    s_lshl_b32 s26, s40, 7
    s_add_u32 s40, s40, s30
    v_add_u32 v2, s40, v2
    v_mul_u32_u24 v2, 1280, v2
    v_xor_b32 v5, v3, v4
    v_xor_b32 v6, 4, v5
    v_lshl_add_u32 v5, v5, 4, v2
    v_lshl_add_u32 v6, v6, 4, v2
    v_add_u32 v16, 0, v5
    v_add_u32 v17, 9216, v6
    v_add_u32 v18, 18432, v5
    v_add_u32 v19, 27648, v6
    v_add_u32 v20, 40960, v5
    v_add_u32 v21, 50176, v6
    v_add_u32 v22, 59392, v5
    v_add_u32 v23, 68608, v6
    s_mov_b32 s21, 0
    s_mov_b32 s22, 0
    s_mov_b32 s23, 0
    s_and_b32 s21, s2, 7
    s_lshl_b32 s21, s21, 7
    s_mov_b32 s20, 0
    s_mov_b32 m0, s26
    s_waitcnt lgkmcnt(0)
    s_mov_b32 s8, s4
    s_mov_b32 s9, s5
    s_mov_b32 s10, 0x280000
    s_mov_b32 s11, 0x00020000
    buffer_load_dwordx4 v16, s[8:11], s21 offen offset:0 lds
    buffer_load_dwordx4 v17, s[8:11], s21 offen offset:1024 lds
    buffer_load_dwordx4 v18, s[8:11], s21 offen offset:2048 lds
    buffer_load_dwordx4 v19, s[8:11], s21 offen offset:3072 lds
    s_add_u32 m0, m0, 4096
    s_nop 0
    buffer_load_dwordx4 v20, s[8:11], s21 offen offset:0 lds
    buffer_load_dwordx4 v21, s[8:11], s21 offen offset:1024 lds
    buffer_load_dwordx4 v22, s[8:11], s21 offen offset:2048 lds
    buffer_load_dwordx4 v23, s[8:11], s21 offen offset:3072 lds
    s_cmp_eq_u32 s28, 2
    s_cbranch_scc1 k1_ldh
k1_ldq:
    v_add_u32 v24, 81920, v5
    v_add_u32 v25, 91136, v6
    v_add_u32 v26, 100352, v5
    v_add_u32 v27, 109568, v6
    v_add_u32 v28, 122880, v5
    v_add_u32 v29, 132096, v6
    v_add_u32 v30, 141312, v5
    v_add_u32 v31, 150528, v6
    s_mul_i32 s27, s25, 8192
    s_add_u32 s27, s27, 32768
    s_add_u32 m0, m0, 4096
    s_nop 0
    buffer_load_dwordx4 v24, s[8:11], s21 offen offset:0 lds
    buffer_load_dwordx4 v25, s[8:11], s21 offen offset:1024 lds
    buffer_load_dwordx4 v26, s[8:11], s21 offen offset:2048 lds
    buffer_load_dwordx4 v27, s[8:11], s21 offen offset:3072 lds
    s_add_u32 m0, m0, 4096
    s_nop 0
    buffer_load_dwordx4 v28, s[8:11], s21 offen offset:0 lds
    buffer_load_dwordx4 v29, s[8:11], s21 offen offset:1024 lds
    buffer_load_dwordx4 v30, s[8:11], s21 offen offset:2048 lds
    buffer_load_dwordx4 v31, s[8:11], s21 offen offset:3072 lds
    s_mul_i32 s41, s25, 512
    s_lshl_b32 s42, s31, 1
    v_add_u32 v7, s41, v1
    v_lshrrev_b32 v8, 4, v7
    v_and_b32 v9, 15, v7
    v_and_b32 v10, 3, v8
    v_lshlrev_b32 v10, 2, v10
    v_xor_b32 v9, v9, v10
    v_mul_u32_u24 v8, 3840, v8
    v_lshl_add_u32 v8, v9, 4, v8
    v_add_u32 v8, s42, v8
    v_mov_b32 v32, v8
    v_add_u32 v7, s41, v1
    v_add_u32 v7, 64, v7
    v_lshrrev_b32 v8, 4, v7
    v_and_b32 v9, 15, v7
    v_and_b32 v10, 3, v8
    v_lshlrev_b32 v10, 2, v10
    v_xor_b32 v9, v9, v10
    v_mul_u32_u24 v8, 3840, v8
    v_lshl_add_u32 v8, v9, 4, v8
    v_add_u32 v8, s42, v8
    v_subrev_u32 v33, 1024, v8
    v_add_u32 v7, s41, v1
    v_add_u32 v7, 128, v7
    v_lshrrev_b32 v8, 4, v7
    v_and_b32 v9, 15, v7
    v_and_b32 v10, 3, v8
    v_lshlrev_b32 v10, 2, v10
    v_xor_b32 v9, v9, v10
    v_mul_u32_u24 v8, 3840, v8
    v_lshl_add_u32 v8, v9, 4, v8
    v_add_u32 v8, s42, v8
    v_subrev_u32 v34, 2048, v8
    v_add_u32 v7, s41, v1
    v_add_u32 v7, 192, v7
    v_lshrrev_b32 v8, 4, v7
    v_and_b32 v9, 15, v7
    v_and_b32 v10, 3, v8
    v_lshlrev_b32 v10, 2, v10
    v_xor_b32 v9, v9, v10
    v_mul_u32_u24 v8, 3840, v8
    v_lshl_add_u32 v8, v9, 4, v8
    v_add_u32 v8, s42, v8
    v_subrev_u32 v35, 3072, v8
    v_add_u32 v7, s41, v1
    v_add_u32 v7, 256, v7
    v_lshrrev_b32 v8, 4, v7
    v_and_b32 v9, 15, v7
    v_and_b32 v10, 3, v8
    v_lshlrev_b32 v10, 2, v10
    v_xor_b32 v9, v9, v10
    v_mul_u32_u24 v8, 3840, v8
    v_lshl_add_u32 v8, v9, 4, v8
    v_add_u32 v8, s42, v8
    v_mov_b32 v36, v8
    v_add_u32 v7, s41, v1
    v_add_u32 v7, 320, v7
    v_lshrrev_b32 v8, 4, v7
    v_and_b32 v9, 15, v7
    v_and_b32 v10, 3, v8
    v_lshlrev_b32 v10, 2, v10
    v_xor_b32 v9, v9, v10
    v_mul_u32_u24 v8, 3840, v8
    v_lshl_add_u32 v8, v9, 4, v8
    v_add_u32 v8, s42, v8
    v_subrev_u32 v37, 1024, v8
    v_add_u32 v7, s41, v1
    v_add_u32 v7, 384, v7
    v_lshrrev_b32 v8, 4, v7
    v_and_b32 v9, 15, v7
    v_and_b32 v10, 3, v8
    v_lshlrev_b32 v10, 2, v10
    v_xor_b32 v9, v9, v10
    v_mul_u32_u24 v8, 3840, v8
    v_lshl_add_u32 v8, v9, 4, v8
    v_add_u32 v8, s42, v8
    v_subrev_u32 v38, 2048, v8
    v_add_u32 v7, s41, v1
    v_add_u32 v7, 448, v7
    v_lshrrev_b32 v8, 4, v7
    v_and_b32 v9, 15, v7
    v_and_b32 v10, 3, v8
    v_lshlrev_b32 v10, 2, v10
    v_xor_b32 v9, v9, v10
    v_mul_u32_u24 v8, 3840, v8
    v_lshl_add_u32 v8, v9, 4, v8
    v_add_u32 v8, s42, v8
    v_subrev_u32 v39, 3072, v8
    s_mov_b32 s12, s6
    s_mov_b32 s13, s7
    s_mov_b32 s14, 0x258000
    s_mov_b32 s15, 0x00020000
    s_mul_i32 s22, s21, 1920
    s_add_u32 m0, s23, s27
    s_nop 0
    buffer_load_dwordx4 v32, s[12:15], s22 offen offset:0 lds
    buffer_load_dwordx4 v33, s[12:15], s22 offen offset:1024 lds
    buffer_load_dwordx4 v34, s[12:15], s22 offen offset:2048 lds
    buffer_load_dwordx4 v35, s[12:15], s22 offen offset:3072 lds
    s_add_u32 m0, m0, 4096
    s_nop 0
    buffer_load_dwordx4 v36, s[12:15], s22 offen offset:0 lds
    buffer_load_dwordx4 v37, s[12:15], s22 offen offset:1024 lds
    buffer_load_dwordx4 v38, s[12:15], s22 offen offset:2048 lds
    buffer_load_dwordx4 v39, s[12:15], s22 offen offset:3072 lds
    s_add_u32 s21, s21, 128
    s_add_u32 s22, s22, 245760
    s_cmp_eq_u32 s21, 1280
    s_cselect_b32 s21, 0, s21
    s_cselect_b32 s22, 0, s22
    s_add_u32 s23, s23, 49152
    s_cmp_eq_u32 s23, 147456
    s_cselect_b32 s23, 0, s23
    s_add_u32 m0, s23, s27
    s_nop 0
    buffer_load_dwordx4 v32, s[12:15], s22 offen offset:0 lds
    buffer_load_dwordx4 v33, s[12:15], s22 offen offset:1024 lds
    buffer_load_dwordx4 v34, s[12:15], s22 offen offset:2048 lds
    buffer_load_dwordx4 v35, s[12:15], s22 offen offset:3072 lds
    s_add_u32 m0, m0, 4096
    s_nop 0
    buffer_load_dwordx4 v36, s[12:15], s22 offen offset:0 lds
    buffer_load_dwordx4 v37, s[12:15], s22 offen offset:1024 lds
    buffer_load_dwordx4 v38, s[12:15], s22 offen offset:2048 lds
    buffer_load_dwordx4 v39, s[12:15], s22 offen offset:3072 lds
    s_waitcnt vmcnt(8)
    s_barrier
    s_add_u32 m0, s23, s26
    s_nop 0
    buffer_load_dwordx4 v16, s[8:11], s21 offen offset:0 lds
    buffer_load_dwordx4 v17, s[8:11], s21 offen offset:1024 lds
    buffer_load_dwordx4 v18, s[8:11], s21 offen offset:2048 lds
    buffer_load_dwordx4 v19, s[8:11], s21 offen offset:3072 lds
    s_add_u32 m0, m0, 4096
    s_nop 0
    buffer_load_dwordx4 v20, s[8:11], s21 offen offset:0 lds
    buffer_load_dwordx4 v21, s[8:11], s21 offen offset:1024 lds
    buffer_load_dwordx4 v22, s[8:11], s21 offen offset:2048 lds
    buffer_load_dwordx4 v23, s[8:11], s21 offen offset:3072 lds
    s_add_u32 m0, m0, 4096
    s_nop 0
    buffer_load_dwordx4 v24, s[8:11], s21 offen offset:0 lds
    buffer_load_dwordx4 v25, s[8:11], s21 offen offset:1024 lds
    buffer_load_dwordx4 v26, s[8:11], s21 offen offset:2048 lds
    buffer_load_dwordx4 v27, s[8:11], s21 offen offset:3072 lds
    s_add_u32 m0, m0, 4096
    s_nop 0
    buffer_load_dwordx4 v28, s[8:11], s21 offen offset:0 lds
    buffer_load_dwordx4 v29, s[8:11], s21 offen offset:1024 lds
    buffer_load_dwordx4 v30, s[8:11], s21 offen offset:2048 lds
    buffer_load_dwordx4 v31, s[8:11], s21 offen offset:3072 lds
    s_add_u32 s21, s21, 128
    s_add_u32 s22, s22, 245760
    s_cmp_eq_u32 s21, 1280
    s_cselect_b32 s21, 0, s21
    s_cselect_b32 s22, 0, s22
    s_add_u32 s23, s23, 49152
    s_cmp_eq_u32 s23, 147456
    s_cselect_b32 s23, 0, s23
    s_mov_b32 s20, 1
k1_ldq_loop:
    s_add_u32 m0, s23, s26
    s_nop 0
    buffer_load_dwordx4 v16, s[8:11], s21 offen offset:0 lds
    buffer_load_dwordx4 v17, s[8:11], s21 offen offset:1024 lds
    buffer_load_dwordx4 v18, s[8:11], s21 offen offset:2048 lds
    buffer_load_dwordx4 v19, s[8:11], s21 offen offset:3072 lds
    s_add_u32 m0, m0, 4096
    s_nop 0
    buffer_load_dwordx4 v20, s[8:11], s21 offen offset:0 lds
    buffer_load_dwordx4 v21, s[8:11], s21 offen offset:1024 lds
    buffer_load_dwordx4 v22, s[8:11], s21 offen offset:2048 lds
    buffer_load_dwordx4 v23, s[8:11], s21 offen offset:3072 lds
    s_add_u32 m0, m0, 4096
    s_nop 0
    buffer_load_dwordx4 v24, s[8:11], s21 offen offset:0 lds
    buffer_load_dwordx4 v25, s[8:11], s21 offen offset:1024 lds
    buffer_load_dwordx4 v26, s[8:11], s21 offen offset:2048 lds
    buffer_load_dwordx4 v27, s[8:11], s21 offen offset:3072 lds
    s_add_u32 m0, m0, 4096
    s_nop 0
    buffer_load_dwordx4 v28, s[8:11], s21 offen offset:0 lds
    buffer_load_dwordx4 v29, s[8:11], s21 offen offset:1024 lds
    buffer_load_dwordx4 v30, s[8:11], s21 offen offset:2048 lds
    buffer_load_dwordx4 v31, s[8:11], s21 offen offset:3072 lds
    s_add_u32 m0, s23, s27
    s_nop 0
    buffer_load_dwordx4 v32, s[12:15], s22 offen offset:0 lds
    buffer_load_dwordx4 v33, s[12:15], s22 offen offset:1024 lds
    buffer_load_dwordx4 v34, s[12:15], s22 offen offset:2048 lds
    buffer_load_dwordx4 v35, s[12:15], s22 offen offset:3072 lds
    s_add_u32 m0, m0, 4096
    s_nop 0
    buffer_load_dwordx4 v36, s[12:15], s22 offen offset:0 lds
    buffer_load_dwordx4 v37, s[12:15], s22 offen offset:1024 lds
    buffer_load_dwordx4 v38, s[12:15], s22 offen offset:2048 lds
    buffer_load_dwordx4 v39, s[12:15], s22 offen offset:3072 lds
    s_add_u32 s21, s21, 128
    s_add_u32 s22, s22, 245760
    s_cmp_eq_u32 s21, 1280
    s_cselect_b32 s21, 0, s21
    s_cselect_b32 s22, 0, s22
    s_add_u32 s23, s23, 49152
    s_cmp_eq_u32 s23, 147456
    s_cselect_b32 s23, 0, s23
    s_waitcnt vmcnt(24)
    s_barrier
    s_add_u32 s20, s20, 1
    s_cmp_lt_u32 s20, 9
    s_cbranch_scc1 k1_ldq_loop
    s_branch k1_ld_pack
k1_ldh:
    s_mul_i32 s27, s25, 12288
    s_add_u32 s27, s27, 16384
    s_mul_i32 s41, s25, 768
    s_lshl_b32 s42, s31, 1
    v_add_u32 v7, s41, v1
    v_mul_u32_u24 v8, 2731, v7
    v_lshrrev_b32 v8, 16, v8
    v_mul_u32_u24 v9, 24, v8
    v_sub_u32 v9, v7, v9
    v_bfe_u32 v10, v8, 1, 1
    v_lshlrev_b32 v10, 2, v10
    v_xor_b32 v9, v9, v10
    v_mul_u32_u24 v8, 3072, v8
    v_lshl_add_u32 v8, v9, 4, v8
    v_add_u32 v8, s42, v8
    v_mov_b32 v24, v8
    v_add_u32 v7, s41, v1
    v_add_u32 v7, 64, v7
    v_mul_u32_u24 v8, 2731, v7
    v_lshrrev_b32 v8, 16, v8
    v_mul_u32_u24 v9, 24, v8
    v_sub_u32 v9, v7, v9
    v_bfe_u32 v10, v8, 1, 1
    v_lshlrev_b32 v10, 2, v10
    v_xor_b32 v9, v9, v10
    v_mul_u32_u24 v8, 3072, v8
    v_lshl_add_u32 v8, v9, 4, v8
    v_add_u32 v8, s42, v8
    v_subrev_u32 v25, 1024, v8
    v_add_u32 v7, s41, v1
    v_add_u32 v7, 128, v7
    v_mul_u32_u24 v8, 2731, v7
    v_lshrrev_b32 v8, 16, v8
    v_mul_u32_u24 v9, 24, v8
    v_sub_u32 v9, v7, v9
    v_bfe_u32 v10, v8, 1, 1
    v_lshlrev_b32 v10, 2, v10
    v_xor_b32 v9, v9, v10
    v_mul_u32_u24 v8, 3072, v8
    v_lshl_add_u32 v8, v9, 4, v8
    v_add_u32 v8, s42, v8
    v_subrev_u32 v26, 2048, v8
    v_add_u32 v7, s41, v1
    v_add_u32 v7, 192, v7
    v_mul_u32_u24 v8, 2731, v7
    v_lshrrev_b32 v8, 16, v8
    v_mul_u32_u24 v9, 24, v8
    v_sub_u32 v9, v7, v9
    v_bfe_u32 v10, v8, 1, 1
    v_lshlrev_b32 v10, 2, v10
    v_xor_b32 v9, v9, v10
    v_mul_u32_u24 v8, 3072, v8
    v_lshl_add_u32 v8, v9, 4, v8
    v_add_u32 v8, s42, v8
    v_subrev_u32 v27, 3072, v8
    v_add_u32 v7, s41, v1
    v_add_u32 v7, 256, v7
    v_mul_u32_u24 v8, 2731, v7
    v_lshrrev_b32 v8, 16, v8
    v_mul_u32_u24 v9, 24, v8
    v_sub_u32 v9, v7, v9
    v_bfe_u32 v10, v8, 1, 1
    v_lshlrev_b32 v10, 2, v10
    v_xor_b32 v9, v9, v10
    v_mul_u32_u24 v8, 3072, v8
    v_lshl_add_u32 v8, v9, 4, v8
    v_add_u32 v8, s42, v8
    v_mov_b32 v28, v8
    v_add_u32 v7, s41, v1
    v_add_u32 v7, 320, v7
    v_mul_u32_u24 v8, 2731, v7
    v_lshrrev_b32 v8, 16, v8
    v_mul_u32_u24 v9, 24, v8
    v_sub_u32 v9, v7, v9
    v_bfe_u32 v10, v8, 1, 1
    v_lshlrev_b32 v10, 2, v10
    v_xor_b32 v9, v9, v10
    v_mul_u32_u24 v8, 3072, v8
    v_lshl_add_u32 v8, v9, 4, v8
    v_add_u32 v8, s42, v8
    v_subrev_u32 v29, 1024, v8
    v_add_u32 v7, s41, v1
    v_add_u32 v7, 384, v7
    v_mul_u32_u24 v8, 2731, v7
    v_lshrrev_b32 v8, 16, v8
    v_mul_u32_u24 v9, 24, v8
    v_sub_u32 v9, v7, v9
    v_bfe_u32 v10, v8, 1, 1
    v_lshlrev_b32 v10, 2, v10
    v_xor_b32 v9, v9, v10
    v_mul_u32_u24 v8, 3072, v8
    v_lshl_add_u32 v8, v9, 4, v8
    v_add_u32 v8, s42, v8
    v_subrev_u32 v30, 2048, v8
    v_add_u32 v7, s41, v1
    v_add_u32 v7, 448, v7
    v_mul_u32_u24 v8, 2731, v7
    v_lshrrev_b32 v8, 16, v8
    v_mul_u32_u24 v9, 24, v8
    v_sub_u32 v9, v7, v9
    v_bfe_u32 v10, v8, 1, 1
    v_lshlrev_b32 v10, 2, v10
    v_xor_b32 v9, v9, v10
    v_mul_u32_u24 v8, 3072, v8
    v_lshl_add_u32 v8, v9, 4, v8
    v_add_u32 v8, s42, v8
    v_subrev_u32 v31, 3072, v8
    v_add_u32 v7, s41, v1
    v_add_u32 v7, 512, v7
    v_mul_u32_u24 v8, 2731, v7
    v_lshrrev_b32 v8, 16, v8
    v_mul_u32_u24 v9, 24, v8
    v_sub_u32 v9, v7, v9
    v_bfe_u32 v10, v8, 1, 1
    v_lshlrev_b32 v10, 2, v10
    v_xor_b32 v9, v9, v10
    v_mul_u32_u24 v8, 3072, v8
    v_lshl_add_u32 v8, v9, 4, v8
    v_add_u32 v8, s42, v8
    v_mov_b32 v32, v8
    v_add_u32 v7, s41, v1
    v_add_u32 v7, 576, v7
    v_mul_u32_u24 v8, 2731, v7
    v_lshrrev_b32 v8, 16, v8
    v_mul_u32_u24 v9, 24, v8
    v_sub_u32 v9, v7, v9
    v_bfe_u32 v10, v8, 1, 1
    v_lshlrev_b32 v10, 2, v10
    v_xor_b32 v9, v9, v10
    v_mul_u32_u24 v8, 3072, v8
    v_lshl_add_u32 v8, v9, 4, v8
    v_add_u32 v8, s42, v8
    v_subrev_u32 v33, 1024, v8
    v_add_u32 v7, s41, v1
    v_add_u32 v7, 640, v7
    v_mul_u32_u24 v8, 2731, v7
    v_lshrrev_b32 v8, 16, v8
    v_mul_u32_u24 v9, 24, v8
    v_sub_u32 v9, v7, v9
    v_bfe_u32 v10, v8, 1, 1
    v_lshlrev_b32 v10, 2, v10
    v_xor_b32 v9, v9, v10
    v_mul_u32_u24 v8, 3072, v8
    v_lshl_add_u32 v8, v9, 4, v8
    v_add_u32 v8, s42, v8
    v_subrev_u32 v34, 2048, v8
    v_add_u32 v7, s41, v1
    v_add_u32 v7, 704, v7
    v_mul_u32_u24 v8, 2731, v7
    v_lshrrev_b32 v8, 16, v8
    v_mul_u32_u24 v9, 24, v8
    v_sub_u32 v9, v7, v9
    v_bfe_u32 v10, v8, 1, 1
    v_lshlrev_b32 v10, 2, v10
    v_xor_b32 v9, v9, v10
    v_mul_u32_u24 v8, 3072, v8
    v_lshl_add_u32 v8, v9, 4, v8
    v_add_u32 v8, s42, v8
    v_subrev_u32 v35, 3072, v8
    s_mov_b32 s12, s48
    s_mov_b32 s13, s49
    s_mov_b32 s14, 0x1e0000
    s_mov_b32 s15, 0x00020000
    s_mul_i32 s22, s21, 1536
    s_add_u32 m0, s23, s27
    s_nop 0
    buffer_load_dwordx4 v24, s[12:15], s22 offen offset:0 lds
    buffer_load_dwordx4 v25, s[12:15], s22 offen offset:1024 lds
    buffer_load_dwordx4 v26, s[12:15], s22 offen offset:2048 lds
    buffer_load_dwordx4 v27, s[12:15], s22 offen offset:3072 lds
    s_add_u32 m0, m0, 4096
    s_nop 0
    buffer_load_dwordx4 v28, s[12:15], s22 offen offset:0 lds
    buffer_load_dwordx4 v29, s[12:15], s22 offen offset:1024 lds
    buffer_load_dwordx4 v30, s[12:15], s22 offen offset:2048 lds
    buffer_load_dwordx4 v31, s[12:15], s22 offen offset:3072 lds
    s_add_u32 m0, m0, 4096
    s_nop 0
    buffer_load_dwordx4 v32, s[12:15], s22 offen offset:0 lds
    buffer_load_dwordx4 v33, s[12:15], s22 offen offset:1024 lds
    buffer_load_dwordx4 v34, s[12:15], s22 offen offset:2048 lds
    buffer_load_dwordx4 v35, s[12:15], s22 offen offset:3072 lds
    s_add_u32 s21, s21, 128
    s_add_u32 s22, s22, 196608
    s_cmp_eq_u32 s21, 1280
    s_cselect_b32 s21, 0, s21
    s_cselect_b32 s22, 0, s22
    s_add_u32 s23, s23, 40960
    s_cmp_eq_u32 s23, 122880
    s_cselect_b32 s23, 0, s23
    s_add_u32 m0, s23, s27
    s_nop 0
    buffer_load_dwordx4 v24, s[12:15], s22 offen offset:0 lds
    buffer_load_dwordx4 v25, s[12:15], s22 offen offset:1024 lds
    buffer_load_dwordx4 v26, s[12:15], s22 offen offset:2048 lds
    buffer_load_dwordx4 v27, s[12:15], s22 offen offset:3072 lds
    s_add_u32 m0, m0, 4096
    s_nop 0
    buffer_load_dwordx4 v28, s[12:15], s22 offen offset:0 lds
    buffer_load_dwordx4 v29, s[12:15], s22 offen offset:1024 lds
    buffer_load_dwordx4 v30, s[12:15], s22 offen offset:2048 lds
    buffer_load_dwordx4 v31, s[12:15], s22 offen offset:3072 lds
    s_add_u32 m0, m0, 4096
    s_nop 0
    buffer_load_dwordx4 v32, s[12:15], s22 offen offset:0 lds
    buffer_load_dwordx4 v33, s[12:15], s22 offen offset:1024 lds
    buffer_load_dwordx4 v34, s[12:15], s22 offen offset:2048 lds
    buffer_load_dwordx4 v35, s[12:15], s22 offen offset:3072 lds
    s_waitcnt vmcnt(12)
    s_barrier
    s_add_u32 m0, s23, s26
    s_nop 0
    buffer_load_dwordx4 v16, s[8:11], s21 offen offset:0 lds
    buffer_load_dwordx4 v17, s[8:11], s21 offen offset:1024 lds
    buffer_load_dwordx4 v18, s[8:11], s21 offen offset:2048 lds
    buffer_load_dwordx4 v19, s[8:11], s21 offen offset:3072 lds
    s_add_u32 m0, m0, 4096
    s_nop 0
    buffer_load_dwordx4 v20, s[8:11], s21 offen offset:0 lds
    buffer_load_dwordx4 v21, s[8:11], s21 offen offset:1024 lds
    buffer_load_dwordx4 v22, s[8:11], s21 offen offset:2048 lds
    buffer_load_dwordx4 v23, s[8:11], s21 offen offset:3072 lds
    s_add_u32 s21, s21, 128
    s_add_u32 s22, s22, 196608
    s_cmp_eq_u32 s21, 1280
    s_cselect_b32 s21, 0, s21
    s_cselect_b32 s22, 0, s22
    s_add_u32 s23, s23, 40960
    s_cmp_eq_u32 s23, 122880
    s_cselect_b32 s23, 0, s23
    s_mov_b32 s20, 1
k1_ldh_loop:
    s_add_u32 m0, s23, s26
    s_nop 0
    buffer_load_dwordx4 v16, s[8:11], s21 offen offset:0 lds
    buffer_load_dwordx4 v17, s[8:11], s21 offen offset:1024 lds
    buffer_load_dwordx4 v18, s[8:11], s21 offen offset:2048 lds
    buffer_load_dwordx4 v19, s[8:11], s21 offen offset:3072 lds
    s_add_u32 m0, m0, 4096
    s_nop 0
    buffer_load_dwordx4 v20, s[8:11], s21 offen offset:0 lds
    buffer_load_dwordx4 v21, s[8:11], s21 offen offset:1024 lds
    buffer_load_dwordx4 v22, s[8:11], s21 offen offset:2048 lds
    buffer_load_dwordx4 v23, s[8:11], s21 offen offset:3072 lds
    s_add_u32 m0, s23, s27
    s_nop 0
    buffer_load_dwordx4 v24, s[12:15], s22 offen offset:0 lds
    buffer_load_dwordx4 v25, s[12:15], s22 offen offset:1024 lds
    buffer_load_dwordx4 v26, s[12:15], s22 offen offset:2048 lds
    buffer_load_dwordx4 v27, s[12:15], s22 offen offset:3072 lds
    s_add_u32 m0, m0, 4096
    s_nop 0
    buffer_load_dwordx4 v28, s[12:15], s22 offen offset:0 lds
    buffer_load_dwordx4 v29, s[12:15], s22 offen offset:1024 lds
    buffer_load_dwordx4 v30, s[12:15], s22 offen offset:2048 lds
    buffer_load_dwordx4 v31, s[12:15], s22 offen offset:3072 lds
    s_add_u32 m0, m0, 4096
    s_nop 0
    buffer_load_dwordx4 v32, s[12:15], s22 offen offset:0 lds
    buffer_load_dwordx4 v33, s[12:15], s22 offen offset:1024 lds
    buffer_load_dwordx4 v34, s[12:15], s22 offen offset:2048 lds
    buffer_load_dwordx4 v35, s[12:15], s22 offen offset:3072 lds
    s_add_u32 s21, s21, 128
    s_add_u32 s22, s22, 196608
    s_cmp_eq_u32 s21, 1280
    s_cselect_b32 s21, 0, s21
    s_cselect_b32 s22, 0, s22
    s_add_u32 s23, s23, 40960
    s_cmp_eq_u32 s23, 122880
    s_cselect_b32 s23, 0, s23
    s_waitcnt vmcnt(20)
    s_barrier
    s_add_u32 s20, s20, 1
    s_cmp_lt_u32 s20, 9
    s_cbranch_scc1 k1_ldh_loop
    s_branch k1_ld_pack
k1_ld_pack:
    v_bfe_u32 v245, v1, 2, 2
    v_lshrrev_b32 v246, 5, v1
    v_lshlrev_b32 v247, 4, v1
    v_bfe_u32 v249, v1, 4, 1
    v_and_b32 v250, 3, v1
    v_lshlrev_b32 v250, 4, v250
    s_mov_b32 s78, s25
    s_mul_i32 s77, s78, 10240
    s_add_u32 s77, s77, 49152
    v_lshl_add_u32 v251, v246, 3, v245
    v_lshlrev_b32 v251, 6, v251
    v_lshl_add_u32 v251, v249, 5, v251
    v_and_b32 v252, 3, v1
    v_lshl_add_u32 v251, v252, 3, v251
    v_add_u32 v251, s77, v251
    s_cmp_ge_u32 s2, 96
    s_cbranch_scc1 pk_n1
    s_lshl_b32 s34, s2, 4
    s_mov_b32 s35, 4
    s_mov_b32 s36, 8
    s_movk_i32 s37, 1280
    s_mov_b32 s16, s54
    s_mov_b32 s17, s55
    s_mov_b32 s18, 1966080
    s_lshl_b32 s84, s2, 10
    s_mov_b32 s85, 98304
    s_mov_b32 s86, 10
    s_mov_b32 s32, 0
    s_branch pk_go
pk_n1:
    s_cmp_ge_u32 s2, 136
    s_cbranch_scc1 pk_n2
    s_sub_u32 s33, s2, 96
    s_mul_i32 s34, s33, 20
    s_mov_b32 s35, 4
    s_mov_b32 s36, 8
    s_movk_i32 s37, 1280
    s_mov_b32 s16, s52
    s_mov_b32 s17, s53
    s_mov_b32 s18, 819200
    s_lshl_b32 s84, s33, 10
    s_add_u32 s84, s84, 4194304
    s_mov_b32 s85, 40960
    s_mov_b32 s86, 10
    s_mov_b32 s32, 0
    s_cmp_lt_u32 s33, 32
    s_cbranch_scc1 pk_go
    s_sub_u32 s33, s33, 32
    s_mul_i32 s34, s33, 80
    s_add_u32 s34, s34, 16
    s_mov_b32 s35, 40
    s_mov_b32 s36, 20
    s_branch pk_go
pk_n2:
    s_mov_b32 s34, 0
    s_mov_b32 s35, 0
    s_mov_b32 s36, 0
    s_mov_b32 s37, 0
    s_mov_b32 s32, 0
    s_mov_b32 s16, s48
    s_mov_b32 s17, s49
    s_mov_b32 s18, 0
    s_mov_b32 s84, 0x40000000
    s_mov_b32 s85, 0
    s_mov_b32 s86, 10
pk_go:
    s_mov_b32 s19, 0x00020000
    s_mul_i32 s38, s86, s78
    s_add_u32 s32, s32, s38
    s_mul_i32 s38, s32, s85
    s_add_u32 s84, s84, s38
    v_mul_u32_u24 v12, s35, v246
    v_add_u32 v12, s34, v12
    v_add_u32 v12, v12, v245
    v_mul_u32_u24 v248, s36, v249
    v_add_u32 v12, v12, v248
    v_mul_lo_u32 v12, v12, s37
    s_lshl_b32 s32, s32, 6
    v_add_u32 v12, s32, v12
    v_add_u32 v253, v12, v250
    s_mov_b32 s88, s16
    s_mov_b32 s89, s17
    s_mov_b32 s90, s18
    s_mov_b32 s91, s19
    s_add_u32 s64, s58, 0x2000000
    s_addc_u32 s65, s59, 0
    s_mov_b32 s66, 0x800000
    s_mov_b32 s67, 0x00020000
    s_mov_b32 m0, s77
    s_mov_b32 s32, 0
    buffer_load_dwordx4 v253, s[88:91], s32 offen nt lds
    s_add_u32 m0, m0, 1024
    s_add_u32 s32, s32, 64
    buffer_load_dwordx4 v253, s[88:91], s32 offen nt lds
    s_add_u32 m0, m0, 1024
    s_add_u32 s32, s32, 64
    buffer_load_dwordx4 v253, s[88:91], s32 offen nt lds
    s_add_u32 m0, m0, 1024
    s_add_u32 s32, s32, 64
    buffer_load_dwordx4 v253, s[88:91], s32 offen nt lds
    s_add_u32 m0, m0, 1024
    s_add_u32 s32, s32, 64
    buffer_load_dwordx4 v253, s[88:91], s32 offen nt lds
    s_add_u32 m0, m0, 1024
    s_add_u32 s32, s32, 64
    buffer_load_dwordx4 v253, s[88:91], s32 offen nt lds
    s_add_u32 m0, m0, 1024
    s_add_u32 s32, s32, 64
    buffer_load_dwordx4 v253, s[88:91], s32 offen nt lds
    s_add_u32 m0, m0, 1024
    s_add_u32 s32, s32, 64
    buffer_load_dwordx4 v253, s[88:91], s32 offen nt lds
    s_add_u32 m0, m0, 1024
    s_add_u32 s32, s32, 64
    s_cmp_eq_u32 s86, 8
    s_cselect_b32 s90, 0, s90
    buffer_load_dwordx4 v253, s[88:91], s32 offen nt lds
    s_add_u32 m0, m0, 1024
    s_add_u32 s32, s32, 64
    buffer_load_dwordx4 v253, s[88:91], s32 offen nt lds
    s_add_u32 m0, m0, 1024
    s_add_u32 s32, s32, 64
    s_cmp_eq_u32 s28, 3
    s_cbranch_scc1 k1_ld_fin
    s_waitcnt vmcnt(10)
    s_barrier
    s_barrier
k1_ld_fin:
    s_waitcnt vmcnt(0)
    ds_read_b64_tr_b16 v[64:65], v251 offset:0
    ds_read_b64_tr_b16 v[66:67], v251 offset:256
    ds_read_b64_tr_b16 v[68:69], v251 offset:1024
    ds_read_b64_tr_b16 v[70:71], v251 offset:1280
    ds_read_b64_tr_b16 v[72:73], v251 offset:2048
    ds_read_b64_tr_b16 v[74:75], v251 offset:2304
    ds_read_b64_tr_b16 v[76:77], v251 offset:3072
    ds_read_b64_tr_b16 v[78:79], v251 offset:3328
    ds_read_b64_tr_b16 v[80:81], v251 offset:4096
    ds_read_b64_tr_b16 v[82:83], v251 offset:4352
    ds_read_b64_tr_b16 v[84:85], v251 offset:5120
    ds_read_b64_tr_b16 v[86:87], v251 offset:5376
    ds_read_b64_tr_b16 v[88:89], v251 offset:6144
    ds_read_b64_tr_b16 v[90:91], v251 offset:6400
    ds_read_b64_tr_b16 v[92:93], v251 offset:7168
    ds_read_b64_tr_b16 v[94:95], v251 offset:7424
    ds_read_b64_tr_b16 v[96:97], v251 offset:8192
    ds_read_b64_tr_b16 v[98:99], v251 offset:8448
    ds_read_b64_tr_b16 v[100:101], v251 offset:9216
    ds_read_b64_tr_b16 v[102:103], v251 offset:9472
    s_waitcnt lgkmcnt(0)
    buffer_store_dwordx4 v[64:67], v247, s[64:67], s84 offen
    s_add_u32 s84, s84, s85
    buffer_store_dwordx4 v[68:71], v247, s[64:67], s84 offen
    s_add_u32 s84, s84, s85
    buffer_store_dwordx4 v[72:75], v247, s[64:67], s84 offen
    s_add_u32 s84, s84, s85
    buffer_store_dwordx4 v[76:79], v247, s[64:67], s84 offen
    s_add_u32 s84, s84, s85
    buffer_store_dwordx4 v[80:83], v247, s[64:67], s84 offen
    s_add_u32 s84, s84, s85
    buffer_store_dwordx4 v[84:87], v247, s[64:67], s84 offen
    s_add_u32 s84, s84, s85
    buffer_store_dwordx4 v[88:91], v247, s[64:67], s84 offen
    s_add_u32 s84, s84, s85
    buffer_store_dwordx4 v[92:95], v247, s[64:67], s84 offen
    s_add_u32 s84, s84, s85
    s_cmp_eq_u32 s86, 8
    s_cbranch_scc1 pf_1
    buffer_store_dwordx4 v[96:99], v247, s[64:67], s84 offen
    s_add_u32 s84, s84, s85
    buffer_store_dwordx4 v[100:103], v247, s[64:67], s84 offen
    s_add_u32 s84, s84, s85
pf_1:
    s_endpgm
k1_other:
    s_cmp_ge_u32 s25, 4
    s_cbranch_scc1 k1_helper
    s_cmp_eq_u32 s28, 1
    s_cbranch_scc1 k1_v
    s_cmp_eq_u32 s28, 2
    s_cbranch_scc1 k1_h
    s_cmp_eq_u32 s28, 3
    s_cbranch_scc1 k1_done
    s_and_b32 s43, s25, 1
    s_lshr_b32 s44, s25, 1
    v_and_b32 v2, 31, v1
    v_lshrrev_b32 v3, 5, v1
    v_bfe_u32 v4, v2, 1, 3
    s_mul_i32 s45, s43, 16384
    v_lshlrev_b32 v5, 7, v2
    v_add_u32 v5, s45, v5
    v_add_u32 v6, 0, v3
    v_xor_b32 v6, v6, v4
    v_lshl_add_u32 v28, v6, 4, v5
    v_add_u32 v6, 2, v3
    v_xor_b32 v6, v6, v4
    v_lshl_add_u32 v29, v6, 4, v5
    v_add_u32 v6, 4, v3
    v_xor_b32 v6, v6, v4
    v_lshl_add_u32 v30, v6, 4, v5
    v_add_u32 v6, 6, v3
    v_xor_b32 v6, v6, v4
    v_lshl_add_u32 v31, v6, 4, v5
    v_bfe_u32 v6, v1, 2, 2
    v_lshl_add_u32 v7, v3, 3, v6
    v_mul_u32_u24 v7, 256, v7
    v_bfe_u32 v8, v1, 4, 1
    v_lshl_add_u32 v7, v8, 5, v7
    v_and_b32 v8, 3, v1
    v_lshl_add_u32 v7, v8, 3, v7
    v_add_u32 v7, 32768, v7
    s_mul_i32 s46, s44, 2
    s_add_u32 s47, s46, 0
    v_xor_b32 v8, s47, v6
    v_lshl_add_u32 v32, v8, 6, v7
    s_add_u32 s47, s46, 1
    v_xor_b32 v8, s47, v6
    v_lshl_add_u32 v33, v8, 6, v7
    v_mov_b32 v128, 0
    v_mov_b32 v129, 0
    v_mov_b32 v130, 0
    v_mov_b32 v131, 0
    v_mov_b32 v132, 0
    v_mov_b32 v133, 0
    v_mov_b32 v134, 0
    v_mov_b32 v135, 0
    v_mov_b32 v136, 0
    v_mov_b32 v137, 0
    v_mov_b32 v138, 0
    v_mov_b32 v139, 0
    v_mov_b32 v140, 0
    v_mov_b32 v141, 0
    v_mov_b32 v142, 0
    v_mov_b32 v143, 0
    v_mov_b32 v144, 0
    v_mov_b32 v145, 0
    v_mov_b32 v146, 0
    v_mov_b32 v147, 0
    v_mov_b32 v148, 0
    v_mov_b32 v149, 0
    v_mov_b32 v150, 0
    v_mov_b32 v151, 0
    v_mov_b32 v152, 0
    v_mov_b32 v153, 0
    v_mov_b32 v154, 0
    v_mov_b32 v155, 0
    v_mov_b32 v156, 0
    v_mov_b32 v157, 0
    v_mov_b32 v158, 0
    v_mov_b32 v159, 0
    v_mov_b32 v160, 0
    v_mov_b32 v161, 0
    v_mov_b32 v162, 0
    v_mov_b32 v163, 0
    v_mov_b32 v164, 0
    v_mov_b32 v165, 0
    v_mov_b32 v166, 0
    v_mov_b32 v167, 0
    v_mov_b32 v168, 0
    v_mov_b32 v169, 0
    v_mov_b32 v170, 0
    v_mov_b32 v171, 0
    v_mov_b32 v172, 0
    v_mov_b32 v173, 0
    v_mov_b32 v174, 0
    v_mov_b32 v175, 0
    v_mov_b32 v176, 0
    v_mov_b32 v177, 0
    v_mov_b32 v178, 0
    v_mov_b32 v179, 0
    v_mov_b32 v180, 0
    v_mov_b32 v181, 0
    v_mov_b32 v182, 0
    v_mov_b32 v183, 0
    v_mov_b32 v184, 0
    v_mov_b32 v185, 0
    v_mov_b32 v186, 0
    v_mov_b32 v187, 0
    v_mov_b32 v188, 0
    v_mov_b32 v189, 0
    v_mov_b32 v190, 0
    v_mov_b32 v191, 0
    v_mov_b32 v192, 0
    v_mov_b32 v193, 0
    v_mov_b32 v194, 0
    v_mov_b32 v195, 0
    v_mov_b32 v196, 0
    v_mov_b32 v197, 0
    v_mov_b32 v198, 0
    v_mov_b32 v199, 0
    v_mov_b32 v200, 0
    v_mov_b32 v201, 0
    v_mov_b32 v202, 0
    v_mov_b32 v203, 0
    v_mov_b32 v204, 0
    v_mov_b32 v205, 0
    v_mov_b32 v206, 0
    v_mov_b32 v207, 0
    v_mov_b32 v208, 0
    v_mov_b32 v209, 0
    v_mov_b32 v210, 0
    v_mov_b32 v211, 0
    v_mov_b32 v212, 0
    v_mov_b32 v213, 0
    v_mov_b32 v214, 0
    v_mov_b32 v215, 0
    v_mov_b32 v216, 0
    v_mov_b32 v217, 0
    v_mov_b32 v218, 0
    v_mov_b32 v219, 0
    v_mov_b32 v220, 0
    v_mov_b32 v221, 0
    v_mov_b32 v222, 0
    v_mov_b32 v223, 0
    v_mov_b32 v224, 0
    v_mov_b32 v225, 0
    v_mov_b32 v226, 0
    v_mov_b32 v227, 0
    v_mov_b32 v228, 0
    v_mov_b32 v229, 0
    v_mov_b32 v230, 0
    v_mov_b32 v231, 0
    v_mov_b32 v232, 0
    v_mov_b32 v233, 0
    v_mov_b32 v234, 0
    v_mov_b32 v235, 0
    v_mov_b32 v236, 0
    v_mov_b32 v237, 0
    v_mov_b32 v238, 0
    v_mov_b32 v239, 0
    v_mov_b32 v240, 0
    v_mov_b32 v241, 0
    v_mov_b32 v242, 0
    v_mov_b32 v243, 0
    v_mov_b32 v244, 0
    v_mov_b32 v245, 0
    v_mov_b32 v246, 0
    v_mov_b32 v247, 0
    v_mov_b32 v248, 0
    v_mov_b32 v249, 0
    v_mov_b32 v250, 0
    v_mov_b32 v251, 0
    v_mov_b32 v252, 0
    v_mov_b32 v253, 0
    v_mov_b32 v254, 0
    v_mov_b32 v255, 0
    s_mov_b32 s24, 0
    s_mov_b32 s20, 0
    v_add_u32 v36, s24, v28
    v_add_u32 v37, s24, v29
    v_add_u32 v38, s24, v30
    v_add_u32 v39, s24, v31
    v_add_u32 v40, s24, v32
    v_add_u32 v41, s24, v33
    s_setprio 2
    s_waitcnt lgkmcnt(0)
    s_barrier
    ds_read_b128 v[48:51], v36 offset:0
    ds_read_b128 v[52:55], v36 offset:4096
    ds_read_b128 v[56:59], v36 offset:8192
    ds_read_b128 v[60:63], v36 offset:12288
    ds_read_b64_tr_b16 v[80:81], v40 offset:0
    ds_read_b64_tr_b16 v[82:83], v40 offset:1024
    ds_read_b64_tr_b16 v[84:85], v41 offset:0
    ds_read_b64_tr_b16 v[86:87], v41 offset:1024
k1qk_loop:
    s_waitcnt lgkmcnt(0)
    v_mfma_f32_32x32x16_bf16 v[128:143], v[80:83], v[48:51], v[128:143]
    ds_read_b128 v[64:67], v37 offset:0
    ds_read_b128 v[68:71], v37 offset:4096
    v_mfma_f32_32x32x16_bf16 v[144:159], v[84:87], v[48:51], v[144:159]
    ds_read_b128 v[72:75], v37 offset:8192
    ds_read_b128 v[76:79], v37 offset:12288
    v_mfma_f32_32x32x16_bf16 v[160:175], v[80:83], v[52:55], v[160:175]
    ds_read_b64_tr_b16 v[92:93], v40 offset:4096
    ds_read_b64_tr_b16 v[94:95], v40 offset:5120
    v_mfma_f32_32x32x16_bf16 v[176:191], v[84:87], v[52:55], v[176:191]
    ds_read_b64_tr_b16 v[96:97], v41 offset:4096
    ds_read_b64_tr_b16 v[98:99], v41 offset:5120
    v_mfma_f32_32x32x16_bf16 v[192:207], v[80:83], v[56:59], v[192:207]
    v_mfma_f32_32x32x16_bf16 v[208:223], v[84:87], v[56:59], v[208:223]
    v_mfma_f32_32x32x16_bf16 v[224:239], v[80:83], v[60:63], v[224:239]
    v_mfma_f32_32x32x16_bf16 v[240:255], v[84:87], v[60:63], v[240:255]
    s_waitcnt lgkmcnt(0)
    v_mfma_f32_32x32x16_bf16 v[128:143], v[92:95], v[64:67], v[128:143]
    ds_read_b128 v[48:51], v38 offset:0
    ds_read_b128 v[52:55], v38 offset:4096
    v_mfma_f32_32x32x16_bf16 v[144:159], v[96:99], v[64:67], v[144:159]
    ds_read_b128 v[56:59], v38 offset:8192
    ds_read_b128 v[60:63], v38 offset:12288
    v_mfma_f32_32x32x16_bf16 v[160:175], v[92:95], v[68:71], v[160:175]
    ds_read_b64_tr_b16 v[80:81], v40 offset:8192
    ds_read_b64_tr_b16 v[82:83], v40 offset:9216
    v_mfma_f32_32x32x16_bf16 v[176:191], v[96:99], v[68:71], v[176:191]
    ds_read_b64_tr_b16 v[84:85], v41 offset:8192
    ds_read_b64_tr_b16 v[86:87], v41 offset:9216
    v_mfma_f32_32x32x16_bf16 v[192:207], v[92:95], v[72:75], v[192:207]
    v_mfma_f32_32x32x16_bf16 v[208:223], v[96:99], v[72:75], v[208:223]
    v_mfma_f32_32x32x16_bf16 v[224:239], v[92:95], v[76:79], v[224:239]
    v_mfma_f32_32x32x16_bf16 v[240:255], v[96:99], v[76:79], v[240:255]
    s_add_u32 s24, s24, 49152
    s_cmp_eq_u32 s24, 147456
    s_cselect_b32 s24, 0, s24
    s_waitcnt lgkmcnt(0)
    v_mfma_f32_32x32x16_bf16 v[128:143], v[80:83], v[48:51], v[128:143]
    ds_read_b128 v[64:67], v39 offset:0
    ds_read_b128 v[68:71], v39 offset:4096
    v_mfma_f32_32x32x16_bf16 v[144:159], v[84:87], v[48:51], v[144:159]
    ds_read_b128 v[72:75], v39 offset:8192
    ds_read_b128 v[76:79], v39 offset:12288
    v_mfma_f32_32x32x16_bf16 v[160:175], v[80:83], v[52:55], v[160:175]
    ds_read_b64_tr_b16 v[92:93], v40 offset:12288
    ds_read_b64_tr_b16 v[94:95], v40 offset:13312
    v_mfma_f32_32x32x16_bf16 v[176:191], v[84:87], v[52:55], v[176:191]
    ds_read_b64_tr_b16 v[96:97], v41 offset:12288
    ds_read_b64_tr_b16 v[98:99], v41 offset:13312
    v_mfma_f32_32x32x16_bf16 v[192:207], v[80:83], v[56:59], v[192:207]
    v_mfma_f32_32x32x16_bf16 v[208:223], v[84:87], v[56:59], v[208:223]
    v_mfma_f32_32x32x16_bf16 v[224:239], v[80:83], v[60:63], v[224:239]
    v_add_u32 v36, s24, v28
    v_add_u32 v37, s24, v29
    v_add_u32 v38, s24, v30
    v_add_u32 v39, s24, v31
    v_mfma_f32_32x32x16_bf16 v[240:255], v[84:87], v[60:63], v[240:255]
    v_add_u32 v40, s24, v32
    v_add_u32 v41, s24, v33
    s_waitcnt lgkmcnt(0)
    s_barrier
    v_mfma_f32_32x32x16_bf16 v[128:143], v[92:95], v[64:67], v[128:143]
    ds_read_b128 v[48:51], v36 offset:0
    ds_read_b128 v[52:55], v36 offset:4096
    v_mfma_f32_32x32x16_bf16 v[144:159], v[96:99], v[64:67], v[144:159]
    ds_read_b128 v[56:59], v36 offset:8192
    ds_read_b128 v[60:63], v36 offset:12288
    v_mfma_f32_32x32x16_bf16 v[160:175], v[92:95], v[68:71], v[160:175]
    ds_read_b64_tr_b16 v[80:81], v40 offset:0
    ds_read_b64_tr_b16 v[82:83], v40 offset:1024
    v_mfma_f32_32x32x16_bf16 v[176:191], v[96:99], v[68:71], v[176:191]
    ds_read_b64_tr_b16 v[84:85], v41 offset:0
    ds_read_b64_tr_b16 v[86:87], v41 offset:1024
    v_mfma_f32_32x32x16_bf16 v[192:207], v[92:95], v[72:75], v[192:207]
    v_mfma_f32_32x32x16_bf16 v[208:223], v[96:99], v[72:75], v[208:223]
    v_mfma_f32_32x32x16_bf16 v[224:239], v[92:95], v[76:79], v[224:239]
    v_mfma_f32_32x32x16_bf16 v[240:255], v[96:99], v[76:79], v[240:255]
    s_add_u32 s20, s20, 1
    s_cmp_lt_u32 s20, 10
    s_cbranch_scc1 k1qk_loop
    s_waitcnt lgkmcnt(0)
    v_and_b32 v2, 31, v1
    v_lshrrev_b32 v3, 5, v1
    s_lshl_b32 s32, s43, 10
    s_add_u32 s32, s32, 147456
    v_lshl_add_u32 v12, v2, 3, s32
    ds_read_b64 v[4:5], v12 offset:0
    ds_read_b64 v[6:7], v12 offset:256
    ds_read_b64 v[8:9], v12 offset:512
    ds_read_b64 v[10:11], v12 offset:768
    s_lshl_b32 s32, s44, 8
    s_add_u32 s32, s32, 151552
    v_lshl_add_u32 v12, v3, 4, s32
    ds_read_b128 v[48:51], v12 offset:0
    ds_read_b128 v[52:55], v12 offset:32
    ds_read_b128 v[56:59], v12 offset:64
    ds_read_b128 v[60:63], v12 offset:96
    ds_read_b128 v[64:67], v12 offset:128
    ds_read_b128 v[68:71], v12 offset:160
    ds_read_b128 v[72:75], v12 offset:192
    ds_read_b128 v[76:79], v12 offset:224
    s_cmp_ge_u32 s75, 5
    s_cselect_b32 s36, 524288, 0
    s_add_u32 s16, s58, 0x600000
    s_addc_u32 s17, s59, 0
    s_mov_b32 s18, 0x580000
    s_mov_b32 s19, 0x00020000
    s_lshl_b32 s38, s75, 4
    s_lshl_b32 s32, s44, 3
    s_add_u32 s38, s38, s32
    s_lshl_b32 s38, s38, 15
    s_add_u32 s38, s38, s36
    s_lshl_b32 s32, s43, 7
    s_add_u32 s32, s32, s30
    s_lshl_b32 s32, s32, 4
    s_add_u32 s38, s38, s32
    s_add_u32 s39, s38, 65536
    s_add_u32 s40, s39, 65536
    s_add_u32 s41, s40, 65536
    v_lshlrev_b32 v3, 15, v3
    v_lshl_add_u32 v16, v2, 4, v3
    s_waitcnt lgkmcnt(0)
    v_pk_mul_f32 v[80:81], v[48:49], v[4:5] op_sel:[0,1] op_sel_hi:[1,1]
    v_pk_mul_f32 v[82:83], v[50:51], v[4:5] op_sel:[0,1] op_sel_hi:[1,1]
    v_pk_mul_f32 v[84:85], v[52:53], v[4:5] op_sel:[0,1] op_sel_hi:[1,1]
    v_pk_mul_f32 v[86:87], v[54:55], v[4:5] op_sel:[0,1] op_sel_hi:[1,1]
    v_pk_mul_f32 v[88:89], v[56:57], v[4:5] op_sel:[0,1] op_sel_hi:[1,1]
    v_pk_mul_f32 v[90:91], v[58:59], v[4:5] op_sel:[0,1] op_sel_hi:[1,1]
    v_pk_mul_f32 v[92:93], v[60:61], v[4:5] op_sel:[0,1] op_sel_hi:[1,1]
    v_pk_mul_f32 v[94:95], v[62:63], v[4:5] op_sel:[0,1] op_sel_hi:[1,1]
    v_pk_fma_f32 v[128:129], v[128:129], v[4:5], v[80:81] op_sel_hi:[1,0,1] neg_lo:[0,0,1] neg_hi:[0,0,1]
    v_pk_fma_f32 v[130:131], v[130:131], v[4:5], v[82:83] op_sel_hi:[1,0,1] neg_lo:[0,0,1] neg_hi:[0,0,1]
    v_pk_fma_f32 v[132:133], v[132:133], v[4:5], v[84:85] op_sel_hi:[1,0,1] neg_lo:[0,0,1] neg_hi:[0,0,1]
    v_pk_fma_f32 v[134:135], v[134:135], v[4:5], v[86:87] op_sel_hi:[1,0,1] neg_lo:[0,0,1] neg_hi:[0,0,1]
    v_pk_fma_f32 v[136:137], v[136:137], v[4:5], v[88:89] op_sel_hi:[1,0,1] neg_lo:[0,0,1] neg_hi:[0,0,1]
    v_pk_fma_f32 v[138:139], v[138:139], v[4:5], v[90:91] op_sel_hi:[1,0,1] neg_lo:[0,0,1] neg_hi:[0,0,1]
    v_pk_fma_f32 v[140:141], v[140:141], v[4:5], v[92:93] op_sel_hi:[1,0,1] neg_lo:[0,0,1] neg_hi:[0,0,1]
    v_pk_fma_f32 v[142:143], v[142:143], v[4:5], v[94:95] op_sel_hi:[1,0,1] neg_lo:[0,0,1] neg_hi:[0,0,1]
    v_cvt_pk_bf16_f32 v18, v128, v129
    v_cvt_pk_bf16_f32 v19, v130, v131
    v_cvt_pk_bf16_f32 v20, v132, v133
    v_cvt_pk_bf16_f32 v21, v134, v135
    v_cvt_pk_bf16_f32 v22, v136, v137
    v_cvt_pk_bf16_f32 v23, v138, v139
    v_cvt_pk_bf16_f32 v24, v140, v141
    v_cvt_pk_bf16_f32 v25, v142, v143
    s_nop 0
    v_permlane32_swap_b32 v18, v20
    v_permlane32_swap_b32 v19, v21
    v_permlane32_swap_b32 v22, v24
    v_permlane32_swap_b32 v23, v25
    buffer_store_dwordx4 v[18:21], v16, s[16:19], s38 offen offset:0
    buffer_store_dwordx4 v[22:25], v16, s[16:19], s39 offen offset:0
    v_pk_mul_f32 v[80:81], v[64:65], v[4:5] op_sel:[0,1] op_sel_hi:[1,1]
    v_pk_mul_f32 v[82:83], v[66:67], v[4:5] op_sel:[0,1] op_sel_hi:[1,1]
    v_pk_mul_f32 v[84:85], v[68:69], v[4:5] op_sel:[0,1] op_sel_hi:[1,1]
    v_pk_mul_f32 v[86:87], v[70:71], v[4:5] op_sel:[0,1] op_sel_hi:[1,1]
    v_pk_mul_f32 v[88:89], v[72:73], v[4:5] op_sel:[0,1] op_sel_hi:[1,1]
    v_pk_mul_f32 v[90:91], v[74:75], v[4:5] op_sel:[0,1] op_sel_hi:[1,1]
    v_pk_mul_f32 v[92:93], v[76:77], v[4:5] op_sel:[0,1] op_sel_hi:[1,1]
    v_pk_mul_f32 v[94:95], v[78:79], v[4:5] op_sel:[0,1] op_sel_hi:[1,1]
    v_pk_fma_f32 v[144:145], v[144:145], v[4:5], v[80:81] op_sel_hi:[1,0,1] neg_lo:[0,0,1] neg_hi:[0,0,1]
    v_pk_fma_f32 v[146:147], v[146:147], v[4:5], v[82:83] op_sel_hi:[1,0,1] neg_lo:[0,0,1] neg_hi:[0,0,1]
    v_pk_fma_f32 v[148:149], v[148:149], v[4:5], v[84:85] op_sel_hi:[1,0,1] neg_lo:[0,0,1] neg_hi:[0,0,1]
    v_pk_fma_f32 v[150:151], v[150:151], v[4:5], v[86:87] op_sel_hi:[1,0,1] neg_lo:[0,0,1] neg_hi:[0,0,1]
    v_pk_fma_f32 v[152:153], v[152:153], v[4:5], v[88:89] op_sel_hi:[1,0,1] neg_lo:[0,0,1] neg_hi:[0,0,1]
    v_pk_fma_f32 v[154:155], v[154:155], v[4:5], v[90:91] op_sel_hi:[1,0,1] neg_lo:[0,0,1] neg_hi:[0,0,1]
    v_pk_fma_f32 v[156:157], v[156:157], v[4:5], v[92:93] op_sel_hi:[1,0,1] neg_lo:[0,0,1] neg_hi:[0,0,1]
    v_pk_fma_f32 v[158:159], v[158:159], v[4:5], v[94:95] op_sel_hi:[1,0,1] neg_lo:[0,0,1] neg_hi:[0,0,1]
    v_cvt_pk_bf16_f32 v26, v144, v145
    v_cvt_pk_bf16_f32 v27, v146, v147
    v_cvt_pk_bf16_f32 v28, v148, v149
    v_cvt_pk_bf16_f32 v29, v150, v151
    v_cvt_pk_bf16_f32 v30, v152, v153
    v_cvt_pk_bf16_f32 v31, v154, v155
    v_cvt_pk_bf16_f32 v32, v156, v157
    v_cvt_pk_bf16_f32 v33, v158, v159
    s_nop 0
    v_permlane32_swap_b32 v26, v28
    v_permlane32_swap_b32 v27, v29
    v_permlane32_swap_b32 v30, v32
    v_permlane32_swap_b32 v31, v33
    buffer_store_dwordx4 v[26:29], v16, s[16:19], s40 offen offset:0
    buffer_store_dwordx4 v[30:33], v16, s[16:19], s41 offen offset:0
    v_pk_mul_f32 v[80:81], v[48:49], v[6:7] op_sel:[0,1] op_sel_hi:[1,1]
    v_pk_mul_f32 v[82:83], v[50:51], v[6:7] op_sel:[0,1] op_sel_hi:[1,1]
    v_pk_mul_f32 v[84:85], v[52:53], v[6:7] op_sel:[0,1] op_sel_hi:[1,1]
    v_pk_mul_f32 v[86:87], v[54:55], v[6:7] op_sel:[0,1] op_sel_hi:[1,1]
    v_pk_mul_f32 v[88:89], v[56:57], v[6:7] op_sel:[0,1] op_sel_hi:[1,1]
    v_pk_mul_f32 v[90:91], v[58:59], v[6:7] op_sel:[0,1] op_sel_hi:[1,1]
    v_pk_mul_f32 v[92:93], v[60:61], v[6:7] op_sel:[0,1] op_sel_hi:[1,1]
    v_pk_mul_f32 v[94:95], v[62:63], v[6:7] op_sel:[0,1] op_sel_hi:[1,1]
    v_pk_fma_f32 v[160:161], v[160:161], v[6:7], v[80:81] op_sel_hi:[1,0,1] neg_lo:[0,0,1] neg_hi:[0,0,1]
    v_pk_fma_f32 v[162:163], v[162:163], v[6:7], v[82:83] op_sel_hi:[1,0,1] neg_lo:[0,0,1] neg_hi:[0,0,1]
    v_pk_fma_f32 v[164:165], v[164:165], v[6:7], v[84:85] op_sel_hi:[1,0,1] neg_lo:[0,0,1] neg_hi:[0,0,1]
    v_pk_fma_f32 v[166:167], v[166:167], v[6:7], v[86:87] op_sel_hi:[1,0,1] neg_lo:[0,0,1] neg_hi:[0,0,1]
    v_pk_fma_f32 v[168:169], v[168:169], v[6:7], v[88:89] op_sel_hi:[1,0,1] neg_lo:[0,0,1] neg_hi:[0,0,1]
    v_pk_fma_f32 v[170:171], v[170:171], v[6:7], v[90:91] op_sel_hi:[1,0,1] neg_lo:[0,0,1] neg_hi:[0,0,1]
    v_pk_fma_f32 v[172:173], v[172:173], v[6:7], v[92:93] op_sel_hi:[1,0,1] neg_lo:[0,0,1] neg_hi:[0,0,1]
    v_pk_fma_f32 v[174:175], v[174:175], v[6:7], v[94:95] op_sel_hi:[1,0,1] neg_lo:[0,0,1] neg_hi:[0,0,1]
    v_cvt_pk_bf16_f32 v34, v160, v161
    v_cvt_pk_bf16_f32 v35, v162, v163
    v_cvt_pk_bf16_f32 v36, v164, v165
    v_cvt_pk_bf16_f32 v37, v166, v167
    v_cvt_pk_bf16_f32 v38, v168, v169
    v_cvt_pk_bf16_f32 v39, v170, v171
    v_cvt_pk_bf16_f32 v40, v172, v173
    v_cvt_pk_bf16_f32 v41, v174, v175
    s_nop 0
    v_permlane32_swap_b32 v34, v36
    v_permlane32_swap_b32 v35, v37
    v_permlane32_swap_b32 v38, v40
    v_permlane32_swap_b32 v39, v41
    buffer_store_dwordx4 v[34:37], v16, s[16:19], s38 offen offset:512
    buffer_store_dwordx4 v[38:41], v16, s[16:19], s39 offen offset:512
    v_pk_mul_f32 v[80:81], v[64:65], v[6:7] op_sel:[0,1] op_sel_hi:[1,1]
    v_pk_mul_f32 v[82:83], v[66:67], v[6:7] op_sel:[0,1] op_sel_hi:[1,1]
    v_pk_mul_f32 v[84:85], v[68:69], v[6:7] op_sel:[0,1] op_sel_hi:[1,1]
    v_pk_mul_f32 v[86:87], v[70:71], v[6:7] op_sel:[0,1] op_sel_hi:[1,1]
    v_pk_mul_f32 v[88:89], v[72:73], v[6:7] op_sel:[0,1] op_sel_hi:[1,1]
    v_pk_mul_f32 v[90:91], v[74:75], v[6:7] op_sel:[0,1] op_sel_hi:[1,1]
    v_pk_mul_f32 v[92:93], v[76:77], v[6:7] op_sel:[0,1] op_sel_hi:[1,1]
    v_pk_mul_f32 v[94:95], v[78:79], v[6:7] op_sel:[0,1] op_sel_hi:[1,1]
    v_pk_fma_f32 v[176:177], v[176:177], v[6:7], v[80:81] op_sel_hi:[1,0,1] neg_lo:[0,0,1] neg_hi:[0,0,1]
    v_pk_fma_f32 v[178:179], v[178:179], v[6:7], v[82:83] op_sel_hi:[1,0,1] neg_lo:[0,0,1] neg_hi:[0,0,1]
    v_pk_fma_f32 v[180:181], v[180:181], v[6:7], v[84:85] op_sel_hi:[1,0,1] neg_lo:[0,0,1] neg_hi:[0,0,1]
    v_pk_fma_f32 v[182:183], v[182:183], v[6:7], v[86:87] op_sel_hi:[1,0,1] neg_lo:[0,0,1] neg_hi:[0,0,1]
    v_pk_fma_f32 v[184:185], v[184:185], v[6:7], v[88:89] op_sel_hi:[1,0,1] neg_lo:[0,0,1] neg_hi:[0,0,1]
    v_pk_fma_f32 v[186:187], v[186:187], v[6:7], v[90:91] op_sel_hi:[1,0,1] neg_lo:[0,0,1] neg_hi:[0,0,1]
    v_pk_fma_f32 v[188:189], v[188:189], v[6:7], v[92:93] op_sel_hi:[1,0,1] neg_lo:[0,0,1] neg_hi:[0,0,1]
    v_pk_fma_f32 v[190:191], v[190:191], v[6:7], v[94:95] op_sel_hi:[1,0,1] neg_lo:[0,0,1] neg_hi:[0,0,1]
    v_cvt_pk_bf16_f32 v18, v176, v177
    v_cvt_pk_bf16_f32 v19, v178, v179
    v_cvt_pk_bf16_f32 v20, v180, v181
    v_cvt_pk_bf16_f32 v21, v182, v183
    v_cvt_pk_bf16_f32 v22, v184, v185
    v_cvt_pk_bf16_f32 v23, v186, v187
    v_cvt_pk_bf16_f32 v24, v188, v189
    v_cvt_pk_bf16_f32 v25, v190, v191
    s_nop 0
    v_permlane32_swap_b32 v18, v20
    v_permlane32_swap_b32 v19, v21
    v_permlane32_swap_b32 v22, v24
    v_permlane32_swap_b32 v23, v25
    buffer_store_dwordx4 v[18:21], v16, s[16:19], s40 offen offset:512
    buffer_store_dwordx4 v[22:25], v16, s[16:19], s41 offen offset:512
    v_pk_mul_f32 v[80:81], v[48:49], v[8:9] op_sel:[0,1] op_sel_hi:[1,1]
    v_pk_mul_f32 v[82:83], v[50:51], v[8:9] op_sel:[0,1] op_sel_hi:[1,1]
    v_pk_mul_f32 v[84:85], v[52:53], v[8:9] op_sel:[0,1] op_sel_hi:[1,1]
    v_pk_mul_f32 v[86:87], v[54:55], v[8:9] op_sel:[0,1] op_sel_hi:[1,1]
    v_pk_mul_f32 v[88:89], v[56:57], v[8:9] op_sel:[0,1] op_sel_hi:[1,1]
    v_pk_mul_f32 v[90:91], v[58:59], v[8:9] op_sel:[0,1] op_sel_hi:[1,1]
    v_pk_mul_f32 v[92:93], v[60:61], v[8:9] op_sel:[0,1] op_sel_hi:[1,1]
    v_pk_mul_f32 v[94:95], v[62:63], v[8:9] op_sel:[0,1] op_sel_hi:[1,1]
    v_pk_fma_f32 v[192:193], v[192:193], v[8:9], v[80:81] op_sel_hi:[1,0,1] neg_lo:[0,0,1] neg_hi:[0,0,1]
    v_pk_fma_f32 v[194:195], v[194:195], v[8:9], v[82:83] op_sel_hi:[1,0,1] neg_lo:[0,0,1] neg_hi:[0,0,1]
    v_pk_fma_f32 v[196:197], v[196:197], v[8:9], v[84:85] op_sel_hi:[1,0,1] neg_lo:[0,0,1] neg_hi:[0,0,1]
    v_pk_fma_f32 v[198:199], v[198:199], v[8:9], v[86:87] op_sel_hi:[1,0,1] neg_lo:[0,0,1] neg_hi:[0,0,1]
    v_pk_fma_f32 v[200:201], v[200:201], v[8:9], v[88:89] op_sel_hi:[1,0,1] neg_lo:[0,0,1] neg_hi:[0,0,1]
    v_pk_fma_f32 v[202:203], v[202:203], v[8:9], v[90:91] op_sel_hi:[1,0,1] neg_lo:[0,0,1] neg_hi:[0,0,1]
    v_pk_fma_f32 v[204:205], v[204:205], v[8:9], v[92:93] op_sel_hi:[1,0,1] neg_lo:[0,0,1] neg_hi:[0,0,1]
    v_pk_fma_f32 v[206:207], v[206:207], v[8:9], v[94:95] op_sel_hi:[1,0,1] neg_lo:[0,0,1] neg_hi:[0,0,1]
    v_cvt_pk_bf16_f32 v26, v192, v193
    v_cvt_pk_bf16_f32 v27, v194, v195
    v_cvt_pk_bf16_f32 v28, v196, v197
    v_cvt_pk_bf16_f32 v29, v198, v199
    v_cvt_pk_bf16_f32 v30, v200, v201
    v_cvt_pk_bf16_f32 v31, v202, v203
    v_cvt_pk_bf16_f32 v32, v204, v205
    v_cvt_pk_bf16_f32 v33, v206, v207
    s_nop 0
    v_permlane32_swap_b32 v26, v28
    v_permlane32_swap_b32 v27, v29
    v_permlane32_swap_b32 v30, v32
    v_permlane32_swap_b32 v31, v33
    buffer_store_dwordx4 v[26:29], v16, s[16:19], s38 offen offset:1024
    buffer_store_dwordx4 v[30:33], v16, s[16:19], s39 offen offset:1024
    v_pk_mul_f32 v[80:81], v[64:65], v[8:9] op_sel:[0,1] op_sel_hi:[1,1]
    v_pk_mul_f32 v[82:83], v[66:67], v[8:9] op_sel:[0,1] op_sel_hi:[1,1]
    v_pk_mul_f32 v[84:85], v[68:69], v[8:9] op_sel:[0,1] op_sel_hi:[1,1]
    v_pk_mul_f32 v[86:87], v[70:71], v[8:9] op_sel:[0,1] op_sel_hi:[1,1]
    v_pk_mul_f32 v[88:89], v[72:73], v[8:9] op_sel:[0,1] op_sel_hi:[1,1]
    v_pk_mul_f32 v[90:91], v[74:75], v[8:9] op_sel:[0,1] op_sel_hi:[1,1]
    v_pk_mul_f32 v[92:93], v[76:77], v[8:9] op_sel:[0,1] op_sel_hi:[1,1]
    v_pk_mul_f32 v[94:95], v[78:79], v[8:9] op_sel:[0,1] op_sel_hi:[1,1]
    v_pk_fma_f32 v[208:209], v[208:209], v[8:9], v[80:81] op_sel_hi:[1,0,1] neg_lo:[0,0,1] neg_hi:[0,0,1]
    v_pk_fma_f32 v[210:211], v[210:211], v[8:9], v[82:83] op_sel_hi:[1,0,1] neg_lo:[0,0,1] neg_hi:[0,0,1]
    v_pk_fma_f32 v[212:213], v[212:213], v[8:9], v[84:85] op_sel_hi:[1,0,1] neg_lo:[0,0,1] neg_hi:[0,0,1]
    v_pk_fma_f32 v[214:215], v[214:215], v[8:9], v[86:87] op_sel_hi:[1,0,1] neg_lo:[0,0,1] neg_hi:[0,0,1]
    v_pk_fma_f32 v[216:217], v[216:217], v[8:9], v[88:89] op_sel_hi:[1,0,1] neg_lo:[0,0,1] neg_hi:[0,0,1]
    v_pk_fma_f32 v[218:219], v[218:219], v[8:9], v[90:91] op_sel_hi:[1,0,1] neg_lo:[0,0,1] neg_hi:[0,0,1]
    v_pk_fma_f32 v[220:221], v[220:221], v[8:9], v[92:93] op_sel_hi:[1,0,1] neg_lo:[0,0,1] neg_hi:[0,0,1]
    v_pk_fma_f32 v[222:223], v[222:223], v[8:9], v[94:95] op_sel_hi:[1,0,1] neg_lo:[0,0,1] neg_hi:[0,0,1]
    v_cvt_pk_bf16_f32 v34, v208, v209
    v_cvt_pk_bf16_f32 v35, v210, v211
    v_cvt_pk_bf16_f32 v36, v212, v213
    v_cvt_pk_bf16_f32 v37, v214, v215
    v_cvt_pk_bf16_f32 v38, v216, v217
    v_cvt_pk_bf16_f32 v39, v218, v219
    v_cvt_pk_bf16_f32 v40, v220, v221
    v_cvt_pk_bf16_f32 v41, v222, v223
    s_nop 0
    v_permlane32_swap_b32 v34, v36
    v_permlane32_swap_b32 v35, v37
    v_permlane32_swap_b32 v38, v40
    v_permlane32_swap_b32 v39, v41
    buffer_store_dwordx4 v[34:37], v16, s[16:19], s40 offen offset:1024
    buffer_store_dwordx4 v[38:41], v16, s[16:19], s41 offen offset:1024
    v_pk_mul_f32 v[80:81], v[48:49], v[10:11] op_sel:[0,1] op_sel_hi:[1,1]
    v_pk_mul_f32 v[82:83], v[50:51], v[10:11] op_sel:[0,1] op_sel_hi:[1,1]
    v_pk_mul_f32 v[84:85], v[52:53], v[10:11] op_sel:[0,1] op_sel_hi:[1,1]
    v_pk_mul_f32 v[86:87], v[54:55], v[10:11] op_sel:[0,1] op_sel_hi:[1,1]
    v_pk_mul_f32 v[88:89], v[56:57], v[10:11] op_sel:[0,1] op_sel_hi:[1,1]
    v_pk_mul_f32 v[90:91], v[58:59], v[10:11] op_sel:[0,1] op_sel_hi:[1,1]
    v_pk_mul_f32 v[92:93], v[60:61], v[10:11] op_sel:[0,1] op_sel_hi:[1,1]
    v_pk_mul_f32 v[94:95], v[62:63], v[10:11] op_sel:[0,1] op_sel_hi:[1,1]
    v_pk_fma_f32 v[224:225], v[224:225], v[10:11], v[80:81] op_sel_hi:[1,0,1] neg_lo:[0,0,1] neg_hi:[0,0,1]
    v_pk_fma_f32 v[226:227], v[226:227], v[10:11], v[82:83] op_sel_hi:[1,0,1] neg_lo:[0,0,1] neg_hi:[0,0,1]
    v_pk_fma_f32 v[228:229], v[228:229], v[10:11], v[84:85] op_sel_hi:[1,0,1] neg_lo:[0,0,1] neg_hi:[0,0,1]
    v_pk_fma_f32 v[230:231], v[230:231], v[10:11], v[86:87] op_sel_hi:[1,0,1] neg_lo:[0,0,1] neg_hi:[0,0,1]
    v_pk_fma_f32 v[232:233], v[232:233], v[10:11], v[88:89] op_sel_hi:[1,0,1] neg_lo:[0,0,1] neg_hi:[0,0,1]
    v_pk_fma_f32 v[234:235], v[234:235], v[10:11], v[90:91] op_sel_hi:[1,0,1] neg_lo:[0,0,1] neg_hi:[0,0,1]
    v_pk_fma_f32 v[236:237], v[236:237], v[10:11], v[92:93] op_sel_hi:[1,0,1] neg_lo:[0,0,1] neg_hi:[0,0,1]
    v_pk_fma_f32 v[238:239], v[238:239], v[10:11], v[94:95] op_sel_hi:[1,0,1] neg_lo:[0,0,1] neg_hi:[0,0,1]
    v_cvt_pk_bf16_f32 v18, v224, v225
    v_cvt_pk_bf16_f32 v19, v226, v227
    v_cvt_pk_bf16_f32 v20, v228, v229
    v_cvt_pk_bf16_f32 v21, v230, v231
    v_cvt_pk_bf16_f32 v22, v232, v233
    v_cvt_pk_bf16_f32 v23, v234, v235
    v_cvt_pk_bf16_f32 v24, v236, v237
    v_cvt_pk_bf16_f32 v25, v238, v239
    s_nop 0
    v_permlane32_swap_b32 v18, v20
    v_permlane32_swap_b32 v19, v21
    v_permlane32_swap_b32 v22, v24
    v_permlane32_swap_b32 v23, v25
    buffer_store_dwordx4 v[18:21], v16, s[16:19], s38 offen offset:1536
    buffer_store_dwordx4 v[22:25], v16, s[16:19], s39 offen offset:1536
    v_pk_mul_f32 v[80:81], v[64:65], v[10:11] op_sel:[0,1] op_sel_hi:[1,1]
    v_pk_mul_f32 v[82:83], v[66:67], v[10:11] op_sel:[0,1] op_sel_hi:[1,1]
    v_pk_mul_f32 v[84:85], v[68:69], v[10:11] op_sel:[0,1] op_sel_hi:[1,1]
    v_pk_mul_f32 v[86:87], v[70:71], v[10:11] op_sel:[0,1] op_sel_hi:[1,1]
    v_pk_mul_f32 v[88:89], v[72:73], v[10:11] op_sel:[0,1] op_sel_hi:[1,1]
    v_pk_mul_f32 v[90:91], v[74:75], v[10:11] op_sel:[0,1] op_sel_hi:[1,1]
    v_pk_mul_f32 v[92:93], v[76:77], v[10:11] op_sel:[0,1] op_sel_hi:[1,1]
    v_pk_mul_f32 v[94:95], v[78:79], v[10:11] op_sel:[0,1] op_sel_hi:[1,1]
    v_pk_fma_f32 v[240:241], v[240:241], v[10:11], v[80:81] op_sel_hi:[1,0,1] neg_lo:[0,0,1] neg_hi:[0,0,1]
    v_pk_fma_f32 v[242:243], v[242:243], v[10:11], v[82:83] op_sel_hi:[1,0,1] neg_lo:[0,0,1] neg_hi:[0,0,1]
    v_pk_fma_f32 v[244:245], v[244:245], v[10:11], v[84:85] op_sel_hi:[1,0,1] neg_lo:[0,0,1] neg_hi:[0,0,1]
    v_pk_fma_f32 v[246:247], v[246:247], v[10:11], v[86:87] op_sel_hi:[1,0,1] neg_lo:[0,0,1] neg_hi:[0,0,1]
    v_pk_fma_f32 v[248:249], v[248:249], v[10:11], v[88:89] op_sel_hi:[1,0,1] neg_lo:[0,0,1] neg_hi:[0,0,1]
    v_pk_fma_f32 v[250:251], v[250:251], v[10:11], v[90:91] op_sel_hi:[1,0,1] neg_lo:[0,0,1] neg_hi:[0,0,1]
    v_pk_fma_f32 v[252:253], v[252:253], v[10:11], v[92:93] op_sel_hi:[1,0,1] neg_lo:[0,0,1] neg_hi:[0,0,1]
    v_pk_fma_f32 v[254:255], v[254:255], v[10:11], v[94:95] op_sel_hi:[1,0,1] neg_lo:[0,0,1] neg_hi:[0,0,1]
    v_cvt_pk_bf16_f32 v26, v240, v241
    v_cvt_pk_bf16_f32 v27, v242, v243
    v_cvt_pk_bf16_f32 v28, v244, v245
    v_cvt_pk_bf16_f32 v29, v246, v247
    v_cvt_pk_bf16_f32 v30, v248, v249
    v_cvt_pk_bf16_f32 v31, v250, v251
    v_cvt_pk_bf16_f32 v32, v252, v253
    v_cvt_pk_bf16_f32 v33, v254, v255
    s_nop 0
    v_permlane32_swap_b32 v26, v28
    v_permlane32_swap_b32 v27, v29
    v_permlane32_swap_b32 v30, v32
    v_permlane32_swap_b32 v31, v33
    buffer_store_dwordx4 v[26:29], v16, s[16:19], s40 offen offset:1536
    buffer_store_dwordx4 v[30:33], v16, s[16:19], s41 offen offset:1536
    s_endpgm
k1_v:
    s_and_b32 s43, s25, 1
    s_lshr_b32 s44, s25, 1
    v_and_b32 v2, 31, v1
    v_lshrrev_b32 v3, 5, v1
    v_bfe_u32 v4, v2, 1, 3
    s_mul_i32 s45, s43, 16384
    v_lshlrev_b32 v5, 7, v2
    v_add_u32 v5, s45, v5
    v_add_u32 v6, 0, v3
    v_xor_b32 v6, v6, v4
    v_lshl_add_u32 v28, v6, 4, v5
    v_add_u32 v6, 2, v3
    v_xor_b32 v6, v6, v4
    v_lshl_add_u32 v29, v6, 4, v5
    v_add_u32 v6, 4, v3
    v_xor_b32 v6, v6, v4
    v_lshl_add_u32 v30, v6, 4, v5
    v_add_u32 v6, 6, v3
    v_xor_b32 v6, v6, v4
    v_lshl_add_u32 v31, v6, 4, v5
    v_bfe_u32 v6, v1, 2, 2
    v_lshl_add_u32 v7, v3, 3, v6
    v_mul_u32_u24 v7, 256, v7
    v_bfe_u32 v8, v1, 4, 1
    v_lshl_add_u32 v7, v8, 5, v7
    v_and_b32 v8, 3, v1
    v_lshl_add_u32 v7, v8, 3, v7
    v_add_u32 v7, 32768, v7
    s_mul_i32 s46, s44, 2
    s_add_u32 s47, s46, 0
    v_xor_b32 v8, s47, v6
    v_lshl_add_u32 v32, v8, 6, v7
    s_add_u32 s47, s46, 1
    v_xor_b32 v8, s47, v6
    v_lshl_add_u32 v33, v8, 6, v7
    v_mov_b32 v128, 0
    v_mov_b32 v129, 0
    v_mov_b32 v130, 0
    v_mov_b32 v131, 0
    v_mov_b32 v132, 0
    v_mov_b32 v133, 0
    v_mov_b32 v134, 0
    v_mov_b32 v135, 0
    v_mov_b32 v136, 0
    v_mov_b32 v137, 0
    v_mov_b32 v138, 0
    v_mov_b32 v139, 0
    v_mov_b32 v140, 0
    v_mov_b32 v141, 0
    v_mov_b32 v142, 0
    v_mov_b32 v143, 0
    v_mov_b32 v144, 0
    v_mov_b32 v145, 0
    v_mov_b32 v146, 0
    v_mov_b32 v147, 0
    v_mov_b32 v148, 0
    v_mov_b32 v149, 0
    v_mov_b32 v150, 0
    v_mov_b32 v151, 0
    v_mov_b32 v152, 0
    v_mov_b32 v153, 0
    v_mov_b32 v154, 0
    v_mov_b32 v155, 0
    v_mov_b32 v156, 0
    v_mov_b32 v157, 0
    v_mov_b32 v158, 0
    v_mov_b32 v159, 0
    v_mov_b32 v160, 0
    v_mov_b32 v161, 0
    v_mov_b32 v162, 0
    v_mov_b32 v163, 0
    v_mov_b32 v164, 0
    v_mov_b32 v165, 0
    v_mov_b32 v166, 0
    v_mov_b32 v167, 0
    v_mov_b32 v168, 0
    v_mov_b32 v169, 0
    v_mov_b32 v170, 0
    v_mov_b32 v171, 0
    v_mov_b32 v172, 0
    v_mov_b32 v173, 0
    v_mov_b32 v174, 0
    v_mov_b32 v175, 0
    v_mov_b32 v176, 0
    v_mov_b32 v177, 0
    v_mov_b32 v178, 0
    v_mov_b32 v179, 0
    v_mov_b32 v180, 0
    v_mov_b32 v181, 0
    v_mov_b32 v182, 0
    v_mov_b32 v183, 0
    v_mov_b32 v184, 0
    v_mov_b32 v185, 0
    v_mov_b32 v186, 0
    v_mov_b32 v187, 0
    v_mov_b32 v188, 0
    v_mov_b32 v189, 0
    v_mov_b32 v190, 0
    v_mov_b32 v191, 0
    v_mov_b32 v192, 0
    v_mov_b32 v193, 0
    v_mov_b32 v194, 0
    v_mov_b32 v195, 0
    v_mov_b32 v196, 0
    v_mov_b32 v197, 0
    v_mov_b32 v198, 0
    v_mov_b32 v199, 0
    v_mov_b32 v200, 0
    v_mov_b32 v201, 0
    v_mov_b32 v202, 0
    v_mov_b32 v203, 0
    v_mov_b32 v204, 0
    v_mov_b32 v205, 0
    v_mov_b32 v206, 0
    v_mov_b32 v207, 0
    v_mov_b32 v208, 0
    v_mov_b32 v209, 0
    v_mov_b32 v210, 0
    v_mov_b32 v211, 0
    v_mov_b32 v212, 0
    v_mov_b32 v213, 0
    v_mov_b32 v214, 0
    v_mov_b32 v215, 0
    v_mov_b32 v216, 0
    v_mov_b32 v217, 0
    v_mov_b32 v218, 0
    v_mov_b32 v219, 0
    v_mov_b32 v220, 0
    v_mov_b32 v221, 0
    v_mov_b32 v222, 0
    v_mov_b32 v223, 0
    v_mov_b32 v224, 0
    v_mov_b32 v225, 0
    v_mov_b32 v226, 0
    v_mov_b32 v227, 0
    v_mov_b32 v228, 0
    v_mov_b32 v229, 0
    v_mov_b32 v230, 0
    v_mov_b32 v231, 0
    v_mov_b32 v232, 0
    v_mov_b32 v233, 0
    v_mov_b32 v234, 0
    v_mov_b32 v235, 0
    v_mov_b32 v236, 0
    v_mov_b32 v237, 0
    v_mov_b32 v238, 0
    v_mov_b32 v239, 0
    v_mov_b32 v240, 0
    v_mov_b32 v241, 0
    v_mov_b32 v242, 0
    v_mov_b32 v243, 0
    v_mov_b32 v244, 0
    v_mov_b32 v245, 0
    v_mov_b32 v246, 0
    v_mov_b32 v247, 0
    v_mov_b32 v248, 0
    v_mov_b32 v249, 0
    v_mov_b32 v250, 0
    v_mov_b32 v251, 0
    v_mov_b32 v252, 0
    v_mov_b32 v253, 0
    v_mov_b32 v254, 0
    v_mov_b32 v255, 0
    s_mov_b32 s24, 0
    s_mov_b32 s20, 0
    v_add_u32 v36, s24, v28
    v_add_u32 v37, s24, v29
    v_add_u32 v38, s24, v30
    v_add_u32 v39, s24, v31
    v_add_u32 v40, s24, v32
    v_add_u32 v41, s24, v33
    s_setprio 2
    s_waitcnt lgkmcnt(0)
    s_barrier
    ds_read_b128 v[48:51], v36 offset:0
    ds_read_b128 v[52:55], v36 offset:4096
    ds_read_b128 v[56:59], v36 offset:8192
    ds_read_b128 v[60:63], v36 offset:12288
    ds_read_b64_tr_b16 v[80:81], v40 offset:0
    ds_read_b64_tr_b16 v[82:83], v40 offset:1024
    ds_read_b64_tr_b16 v[84:85], v41 offset:0
    ds_read_b64_tr_b16 v[86:87], v41 offset:1024
k1v_loop:
    s_waitcnt lgkmcnt(0)
    v_mfma_f32_32x32x16_bf16 v[128:143], v[48:51], v[80:83], v[128:143]
    ds_read_b128 v[64:67], v37 offset:0
    ds_read_b128 v[68:71], v37 offset:4096
    v_mfma_f32_32x32x16_bf16 v[144:159], v[48:51], v[84:87], v[144:159]
    ds_read_b128 v[72:75], v37 offset:8192
    ds_read_b128 v[76:79], v37 offset:12288
    v_mfma_f32_32x32x16_bf16 v[160:175], v[52:55], v[80:83], v[160:175]
    ds_read_b64_tr_b16 v[92:93], v40 offset:4096
    ds_read_b64_tr_b16 v[94:95], v40 offset:5120
    v_mfma_f32_32x32x16_bf16 v[176:191], v[52:55], v[84:87], v[176:191]
    ds_read_b64_tr_b16 v[96:97], v41 offset:4096
    ds_read_b64_tr_b16 v[98:99], v41 offset:5120
    v_mfma_f32_32x32x16_bf16 v[192:207], v[56:59], v[80:83], v[192:207]
    v_mfma_f32_32x32x16_bf16 v[208:223], v[56:59], v[84:87], v[208:223]
    v_mfma_f32_32x32x16_bf16 v[224:239], v[60:63], v[80:83], v[224:239]
    v_mfma_f32_32x32x16_bf16 v[240:255], v[60:63], v[84:87], v[240:255]
    s_waitcnt lgkmcnt(0)
    v_mfma_f32_32x32x16_bf16 v[128:143], v[64:67], v[92:95], v[128:143]
    ds_read_b128 v[48:51], v38 offset:0
    ds_read_b128 v[52:55], v38 offset:4096
    v_mfma_f32_32x32x16_bf16 v[144:159], v[64:67], v[96:99], v[144:159]
    ds_read_b128 v[56:59], v38 offset:8192
    ds_read_b128 v[60:63], v38 offset:12288
    v_mfma_f32_32x32x16_bf16 v[160:175], v[68:71], v[92:95], v[160:175]
    ds_read_b64_tr_b16 v[80:81], v40 offset:8192
    ds_read_b64_tr_b16 v[82:83], v40 offset:9216
    v_mfma_f32_32x32x16_bf16 v[176:191], v[68:71], v[96:99], v[176:191]
    ds_read_b64_tr_b16 v[84:85], v41 offset:8192
    ds_read_b64_tr_b16 v[86:87], v41 offset:9216
    v_mfma_f32_32x32x16_bf16 v[192:207], v[72:75], v[92:95], v[192:207]
    v_mfma_f32_32x32x16_bf16 v[208:223], v[72:75], v[96:99], v[208:223]
    v_mfma_f32_32x32x16_bf16 v[224:239], v[76:79], v[92:95], v[224:239]
    v_mfma_f32_32x32x16_bf16 v[240:255], v[76:79], v[96:99], v[240:255]
    s_add_u32 s24, s24, 49152
    s_cmp_eq_u32 s24, 147456
    s_cselect_b32 s24, 0, s24
    s_waitcnt lgkmcnt(0)
    v_mfma_f32_32x32x16_bf16 v[128:143], v[48:51], v[80:83], v[128:143]
    ds_read_b128 v[64:67], v39 offset:0
    ds_read_b128 v[68:71], v39 offset:4096
    v_mfma_f32_32x32x16_bf16 v[144:159], v[48:51], v[84:87], v[144:159]
    ds_read_b128 v[72:75], v39 offset:8192
    ds_read_b128 v[76:79], v39 offset:12288
    v_mfma_f32_32x32x16_bf16 v[160:175], v[52:55], v[80:83], v[160:175]
    ds_read_b64_tr_b16 v[92:93], v40 offset:12288
    ds_read_b64_tr_b16 v[94:95], v40 offset:13312
    v_mfma_f32_32x32x16_bf16 v[176:191], v[52:55], v[84:87], v[176:191]
    ds_read_b64_tr_b16 v[96:97], v41 offset:12288
    ds_read_b64_tr_b16 v[98:99], v41 offset:13312
    v_mfma_f32_32x32x16_bf16 v[192:207], v[56:59], v[80:83], v[192:207]
    v_mfma_f32_32x32x16_bf16 v[208:223], v[56:59], v[84:87], v[208:223]
    v_mfma_f32_32x32x16_bf16 v[224:239], v[60:63], v[80:83], v[224:239]
    v_add_u32 v36, s24, v28
    v_add_u32 v37, s24, v29
    v_add_u32 v38, s24, v30
    v_add_u32 v39, s24, v31
    v_mfma_f32_32x32x16_bf16 v[240:255], v[60:63], v[84:87], v[240:255]
    v_add_u32 v40, s24, v32
    v_add_u32 v41, s24, v33
    s_waitcnt lgkmcnt(0)
    s_barrier
    v_mfma_f32_32x32x16_bf16 v[128:143], v[64:67], v[92:95], v[128:143]
    ds_read_b128 v[48:51], v36 offset:0
    ds_read_b128 v[52:55], v36 offset:4096
    v_mfma_f32_32x32x16_bf16 v[144:159], v[64:67], v[96:99], v[144:159]
    ds_read_b128 v[56:59], v36 offset:8192
    ds_read_b128 v[60:63], v36 offset:12288
    v_mfma_f32_32x32x16_bf16 v[160:175], v[68:71], v[92:95], v[160:175]
    ds_read_b64_tr_b16 v[80:81], v40 offset:0
    ds_read_b64_tr_b16 v[82:83], v40 offset:1024
    v_mfma_f32_32x32x16_bf16 v[176:191], v[68:71], v[96:99], v[176:191]
    ds_read_b64_tr_b16 v[84:85], v41 offset:0
    ds_read_b64_tr_b16 v[86:87], v41 offset:1024
    v_mfma_f32_32x32x16_bf16 v[192:207], v[72:75], v[92:95], v[192:207]
    v_mfma_f32_32x32x16_bf16 v[208:223], v[72:75], v[96:99], v[208:223]
    v_mfma_f32_32x32x16_bf16 v[224:239], v[76:79], v[92:95], v[224:239]
    v_mfma_f32_32x32x16_bf16 v[240:255], v[76:79], v[96:99], v[240:255]
    s_add_u32 s20, s20, 1
    s_cmp_lt_u32 s20, 10
    s_cbranch_scc1 k1v_loop
    s_waitcnt lgkmcnt(0)
    v_and_b32 v2, 31, v1
    v_lshrrev_b32 v3, 5, v1
    s_lshl_b32 s32, s43, 9
    s_add_u32 s32, s32, 149504
    v_lshl_add_u32 v12, v3, 4, s32
    s_lshl_b32 s32, s44, 8
    s_add_u32 s32, s32, 151552
    v_lshl_add_u32 v13, v2, 2, s32
    ds_read_b32 v4, v13 offset:0
    ds_read_b32 v6, v13 offset:128
    ds_read_b128 v[48:51], v12 offset:0
    ds_read_b128 v[64:67], v12 offset:1024
    ds_read_b128 v[52:55], v12 offset:32
    ds_read_b128 v[68:71], v12 offset:1056
    ds_read_b128 v[56:59], v12 offset:64
    ds_read_b128 v[72:75], v12 offset:1088
    ds_read_b128 v[60:63], v12 offset:96
    ds_read_b128 v[76:79], v12 offset:1120
    s_add_u32 s16, s58, 0xc00000
    s_addc_u32 s17, s59, 0
    s_mov_b32 s18, 0x2a0000
    s_mov_b32 s19, 0x00020000
    s_lshr_b32 s38, s30, 5
    s_lshl_b32 s32, s43, 2
    s_add_u32 s38, s38, s32
    s_mul_i32 s38, s38, 1344
    s_add_u32 s39, s38, 1344
    s_add_u32 s40, s39, 1344
    s_add_u32 s41, s40, 1344
    s_sub_u32 s33, s31, 1280
    s_lshl_b32 s32, s44, 6
    s_add_u32 s33, s33, s32
    v_mul_u32_u24 v3, 336, v3
    s_mov_b32 s34, 86016
    v_add_u32 v8, s33, v2
    v_mul_u32_u24 v9, 3277, v8
    v_lshrrev_b32 v9, 16, v9
    v_mul_u32_u24 v10, 20, v9
    v_sub_u32 v10, v8, v10
    v_lshl_add_u32 v10, v10, 4, v3
    v_mul_lo_u32 v9, v9, s34
    v_add_u32 v16, v9, v10
    v_add_u32 v8, s33, v2
    v_add_u32 v8, 32, v8
    v_mul_u32_u24 v9, 3277, v8
    v_lshrrev_b32 v9, 16, v9
    v_mul_u32_u24 v10, 20, v9
    v_sub_u32 v10, v8, v10
    v_lshl_add_u32 v10, v10, 4, v3
    v_mul_lo_u32 v9, v9, s34
    v_add_u32 v17, v9, v10
    s_waitcnt lgkmcnt(0)
    ds_read_b128 v[80:83], v12 offset:128
    ds_read_b128 v[96:99], v12 offset:1152
    ds_read_b128 v[84:87], v12 offset:160
    ds_read_b128 v[100:103], v12 offset:1184
    ds_read_b128 v[88:91], v12 offset:192
    ds_read_b128 v[104:107], v12 offset:1216
    ds_read_b128 v[92:95], v12 offset:224
    ds_read_b128 v[108:111], v12 offset:1248
    v_pk_mul_f32 v[112:113], v[64:65], v[4:5] op_sel_hi:[1,0]
    v_pk_mul_f32 v[114:115], v[66:67], v[4:5] op_sel_hi:[1,0]
    v_pk_mul_f32 v[116:117], v[68:69], v[4:5] op_sel_hi:[1,0]
    v_pk_mul_f32 v[118:119], v[70:71], v[4:5] op_sel_hi:[1,0]
    v_pk_mul_f32 v[120:121], v[72:73], v[4:5] op_sel_hi:[1,0]
    v_pk_mul_f32 v[122:123], v[74:75], v[4:5] op_sel_hi:[1,0]
    v_pk_mul_f32 v[124:125], v[76:77], v[4:5] op_sel_hi:[1,0]
    v_pk_mul_f32 v[126:127], v[78:79], v[4:5] op_sel_hi:[1,0]
    v_pk_fma_f32 v[128:129], v[128:129], v[48:49], v[112:113] neg_lo:[0,0,1] neg_hi:[0,0,1]
    v_pk_fma_f32 v[130:131], v[130:131], v[50:51], v[114:115] neg_lo:[0,0,1] neg_hi:[0,0,1]
    v_pk_fma_f32 v[132:133], v[132:133], v[52:53], v[116:117] neg_lo:[0,0,1] neg_hi:[0,0,1]
    v_pk_fma_f32 v[134:135], v[134:135], v[54:55], v[118:119] neg_lo:[0,0,1] neg_hi:[0,0,1]
    v_pk_fma_f32 v[136:137], v[136:137], v[56:57], v[120:121] neg_lo:[0,0,1] neg_hi:[0,0,1]
    v_pk_fma_f32 v[138:139], v[138:139], v[58:59], v[122:123] neg_lo:[0,0,1] neg_hi:[0,0,1]
    v_pk_fma_f32 v[140:141], v[140:141], v[60:61], v[124:125] neg_lo:[0,0,1] neg_hi:[0,0,1]
    v_pk_fma_f32 v[142:143], v[142:143], v[62:63], v[126:127] neg_lo:[0,0,1] neg_hi:[0,0,1]
    v_cvt_pk_bf16_f32 v18, v128, v129
    v_cvt_pk_bf16_f32 v19, v130, v131
    v_cvt_pk_bf16_f32 v20, v132, v133
    v_cvt_pk_bf16_f32 v21, v134, v135
    v_cvt_pk_bf16_f32 v22, v136, v137
    v_cvt_pk_bf16_f32 v23, v138, v139
    v_cvt_pk_bf16_f32 v24, v140, v141
    v_cvt_pk_bf16_f32 v25, v142, v143
    buffer_store_dwordx4 v[18:21], v16, s[16:19], s38 offen
    buffer_store_dwordx4 v[22:25], v16, s[16:19], s38 offen offset:672
    v_pk_mul_f32 v[112:113], v[64:65], v[6:7] op_sel_hi:[1,0]
    v_pk_mul_f32 v[114:115], v[66:67], v[6:7] op_sel_hi:[1,0]
    v_pk_mul_f32 v[116:117], v[68:69], v[6:7] op_sel_hi:[1,0]
    v_pk_mul_f32 v[118:119], v[70:71], v[6:7] op_sel_hi:[1,0]
    v_pk_mul_f32 v[120:121], v[72:73], v[6:7] op_sel_hi:[1,0]
    v_pk_mul_f32 v[122:123], v[74:75], v[6:7] op_sel_hi:[1,0]
    v_pk_mul_f32 v[124:125], v[76:77], v[6:7] op_sel_hi:[1,0]
    v_pk_mul_f32 v[126:127], v[78:79], v[6:7] op_sel_hi:[1,0]
    v_pk_fma_f32 v[144:145], v[144:145], v[48:49], v[112:113] neg_lo:[0,0,1] neg_hi:[0,0,1]
    v_pk_fma_f32 v[146:147], v[146:147], v[50:51], v[114:115] neg_lo:[0,0,1] neg_hi:[0,0,1]
    v_pk_fma_f32 v[148:149], v[148:149], v[52:53], v[116:117] neg_lo:[0,0,1] neg_hi:[0,0,1]
    v_pk_fma_f32 v[150:151], v[150:151], v[54:55], v[118:119] neg_lo:[0,0,1] neg_hi:[0,0,1]
    v_pk_fma_f32 v[152:153], v[152:153], v[56:57], v[120:121] neg_lo:[0,0,1] neg_hi:[0,0,1]
    v_pk_fma_f32 v[154:155], v[154:155], v[58:59], v[122:123] neg_lo:[0,0,1] neg_hi:[0,0,1]
    v_pk_fma_f32 v[156:157], v[156:157], v[60:61], v[124:125] neg_lo:[0,0,1] neg_hi:[0,0,1]
    v_pk_fma_f32 v[158:159], v[158:159], v[62:63], v[126:127] neg_lo:[0,0,1] neg_hi:[0,0,1]
    v_cvt_pk_bf16_f32 v26, v144, v145
    v_cvt_pk_bf16_f32 v27, v146, v147
    v_cvt_pk_bf16_f32 v28, v148, v149
    v_cvt_pk_bf16_f32 v29, v150, v151
    v_cvt_pk_bf16_f32 v30, v152, v153
    v_cvt_pk_bf16_f32 v31, v154, v155
    v_cvt_pk_bf16_f32 v32, v156, v157
    v_cvt_pk_bf16_f32 v33, v158, v159
    buffer_store_dwordx4 v[26:29], v17, s[16:19], s38 offen
    buffer_store_dwordx4 v[30:33], v17, s[16:19], s38 offen offset:672
    s_waitcnt lgkmcnt(0)
    ds_read_b128 v[48:51], v12 offset:256
    ds_read_b128 v[64:67], v12 offset:1280
    ds_read_b128 v[52:55], v12 offset:288
    ds_read_b128 v[68:71], v12 offset:1312
    ds_read_b128 v[56:59], v12 offset:320
    ds_read_b128 v[72:75], v12 offset:1344
    ds_read_b128 v[60:63], v12 offset:352
    ds_read_b128 v[76:79], v12 offset:1376
    v_pk_mul_f32 v[112:113], v[96:97], v[4:5] op_sel_hi:[1,0]
    v_pk_mul_f32 v[114:115], v[98:99], v[4:5] op_sel_hi:[1,0]
    v_pk_mul_f32 v[116:117], v[100:101], v[4:5] op_sel_hi:[1,0]
    v_pk_mul_f32 v[118:119], v[102:103], v[4:5] op_sel_hi:[1,0]
    v_pk_mul_f32 v[120:121], v[104:105], v[4:5] op_sel_hi:[1,0]
    v_pk_mul_f32 v[122:123], v[106:107], v[4:5] op_sel_hi:[1,0]
    v_pk_mul_f32 v[124:125], v[108:109], v[4:5] op_sel_hi:[1,0]
    v_pk_mul_f32 v[126:127], v[110:111], v[4:5] op_sel_hi:[1,0]
    v_pk_fma_f32 v[160:161], v[160:161], v[80:81], v[112:113] neg_lo:[0,0,1] neg_hi:[0,0,1]
    v_pk_fma_f32 v[162:163], v[162:163], v[82:83], v[114:115] neg_lo:[0,0,1] neg_hi:[0,0,1]
    v_pk_fma_f32 v[164:165], v[164:165], v[84:85], v[116:117] neg_lo:[0,0,1] neg_hi:[0,0,1]
    v_pk_fma_f32 v[166:167], v[166:167], v[86:87], v[118:119] neg_lo:[0,0,1] neg_hi:[0,0,1]
    v_pk_fma_f32 v[168:169], v[168:169], v[88:89], v[120:121] neg_lo:[0,0,1] neg_hi:[0,0,1]
    v_pk_fma_f32 v[170:171], v[170:171], v[90:91], v[122:123] neg_lo:[0,0,1] neg_hi:[0,0,1]
    v_pk_fma_f32 v[172:173], v[172:173], v[92:93], v[124:125] neg_lo:[0,0,1] neg_hi:[0,0,1]
    v_pk_fma_f32 v[174:175], v[174:175], v[94:95], v[126:127] neg_lo:[0,0,1] neg_hi:[0,0,1]
    v_cvt_pk_bf16_f32 v34, v160, v161
    v_cvt_pk_bf16_f32 v35, v162, v163
    v_cvt_pk_bf16_f32 v36, v164, v165
    v_cvt_pk_bf16_f32 v37, v166, v167
    v_cvt_pk_bf16_f32 v38, v168, v169
    v_cvt_pk_bf16_f32 v39, v170, v171
    v_cvt_pk_bf16_f32 v40, v172, v173
    v_cvt_pk_bf16_f32 v41, v174, v175
    buffer_store_dwordx4 v[34:37], v16, s[16:19], s39 offen
    buffer_store_dwordx4 v[38:41], v16, s[16:19], s39 offen offset:672
    v_pk_mul_f32 v[112:113], v[96:97], v[6:7] op_sel_hi:[1,0]
    v_pk_mul_f32 v[114:115], v[98:99], v[6:7] op_sel_hi:[1,0]
    v_pk_mul_f32 v[116:117], v[100:101], v[6:7] op_sel_hi:[1,0]
    v_pk_mul_f32 v[118:119], v[102:103], v[6:7] op_sel_hi:[1,0]
    v_pk_mul_f32 v[120:121], v[104:105], v[6:7] op_sel_hi:[1,0]
    v_pk_mul_f32 v[122:123], v[106:107], v[6:7] op_sel_hi:[1,0]
    v_pk_mul_f32 v[124:125], v[108:109], v[6:7] op_sel_hi:[1,0]
    v_pk_mul_f32 v[126:127], v[110:111], v[6:7] op_sel_hi:[1,0]
    v_pk_fma_f32 v[176:177], v[176:177], v[80:81], v[112:113] neg_lo:[0,0,1] neg_hi:[0,0,1]
    v_pk_fma_f32 v[178:179], v[178:179], v[82:83], v[114:115] neg_lo:[0,0,1] neg_hi:[0,0,1]
    v_pk_fma_f32 v[180:181], v[180:181], v[84:85], v[116:117] neg_lo:[0,0,1] neg_hi:[0,0,1]
    v_pk_fma_f32 v[182:183], v[182:183], v[86:87], v[118:119] neg_lo:[0,0,1] neg_hi:[0,0,1]
    v_pk_fma_f32 v[184:185], v[184:185], v[88:89], v[120:121] neg_lo:[0,0,1] neg_hi:[0,0,1]
    v_pk_fma_f32 v[186:187], v[186:187], v[90:91], v[122:123] neg_lo:[0,0,1] neg_hi:[0,0,1]
    v_pk_fma_f32 v[188:189], v[188:189], v[92:93], v[124:125] neg_lo:[0,0,1] neg_hi:[0,0,1]
    v_pk_fma_f32 v[190:191], v[190:191], v[94:95], v[126:127] neg_lo:[0,0,1] neg_hi:[0,0,1]
    v_cvt_pk_bf16_f32 v18, v176, v177
    v_cvt_pk_bf16_f32 v19, v178, v179
    v_cvt_pk_bf16_f32 v20, v180, v181
    v_cvt_pk_bf16_f32 v21, v182, v183
    v_cvt_pk_bf16_f32 v22, v184, v185
    v_cvt_pk_bf16_f32 v23, v186, v187
    v_cvt_pk_bf16_f32 v24, v188, v189
    v_cvt_pk_bf16_f32 v25, v190, v191
    buffer_store_dwordx4 v[18:21], v17, s[16:19], s39 offen
    buffer_store_dwordx4 v[22:25], v17, s[16:19], s39 offen offset:672
    s_waitcnt lgkmcnt(0)
    ds_read_b128 v[80:83], v12 offset:384
    ds_read_b128 v[96:99], v12 offset:1408
    ds_read_b128 v[84:87], v12 offset:416
    ds_read_b128 v[100:103], v12 offset:1440
    ds_read_b128 v[88:91], v12 offset:448
    ds_read_b128 v[104:107], v12 offset:1472
    ds_read_b128 v[92:95], v12 offset:480
    ds_read_b128 v[108:111], v12 offset:1504
    v_pk_mul_f32 v[112:113], v[64:65], v[4:5] op_sel_hi:[1,0]
    v_pk_mul_f32 v[114:115], v[66:67], v[4:5] op_sel_hi:[1,0]
    v_pk_mul_f32 v[116:117], v[68:69], v[4:5] op_sel_hi:[1,0]
    v_pk_mul_f32 v[118:119], v[70:71], v[4:5] op_sel_hi:[1,0]
    v_pk_mul_f32 v[120:121], v[72:73], v[4:5] op_sel_hi:[1,0]
    v_pk_mul_f32 v[122:123], v[74:75], v[4:5] op_sel_hi:[1,0]
    v_pk_mul_f32 v[124:125], v[76:77], v[4:5] op_sel_hi:[1,0]
    v_pk_mul_f32 v[126:127], v[78:79], v[4:5] op_sel_hi:[1,0]
    v_pk_fma_f32 v[192:193], v[192:193], v[48:49], v[112:113] neg_lo:[0,0,1] neg_hi:[0,0,1]
    v_pk_fma_f32 v[194:195], v[194:195], v[50:51], v[114:115] neg_lo:[0,0,1] neg_hi:[0,0,1]
    v_pk_fma_f32 v[196:197], v[196:197], v[52:53], v[116:117] neg_lo:[0,0,1] neg_hi:[0,0,1]
    v_pk_fma_f32 v[198:199], v[198:199], v[54:55], v[118:119] neg_lo:[0,0,1] neg_hi:[0,0,1]
    v_pk_fma_f32 v[200:201], v[200:201], v[56:57], v[120:121] neg_lo:[0,0,1] neg_hi:[0,0,1]
    v_pk_fma_f32 v[202:203], v[202:203], v[58:59], v[122:123] neg_lo:[0,0,1] neg_hi:[0,0,1]
    v_pk_fma_f32 v[204:205], v[204:205], v[60:61], v[124:125] neg_lo:[0,0,1] neg_hi:[0,0,1]
    v_pk_fma_f32 v[206:207], v[206:207], v[62:63], v[126:127] neg_lo:[0,0,1] neg_hi:[0,0,1]
    v_cvt_pk_bf16_f32 v26, v192, v193
    v_cvt_pk_bf16_f32 v27, v194, v195
    v_cvt_pk_bf16_f32 v28, v196, v197
    v_cvt_pk_bf16_f32 v29, v198, v199
    v_cvt_pk_bf16_f32 v30, v200, v201
    v_cvt_pk_bf16_f32 v31, v202, v203
    v_cvt_pk_bf16_f32 v32, v204, v205
    v_cvt_pk_bf16_f32 v33, v206, v207
    buffer_store_dwordx4 v[26:29], v16, s[16:19], s40 offen
    buffer_store_dwordx4 v[30:33], v16, s[16:19], s40 offen offset:672
    v_pk_mul_f32 v[112:113], v[64:65], v[6:7] op_sel_hi:[1,0]
    v_pk_mul_f32 v[114:115], v[66:67], v[6:7] op_sel_hi:[1,0]
    v_pk_mul_f32 v[116:117], v[68:69], v[6:7] op_sel_hi:[1,0]
    v_pk_mul_f32 v[118:119], v[70:71], v[6:7] op_sel_hi:[1,0]
    v_pk_mul_f32 v[120:121], v[72:73], v[6:7] op_sel_hi:[1,0]
    v_pk_mul_f32 v[122:123], v[74:75], v[6:7] op_sel_hi:[1,0]
    v_pk_mul_f32 v[124:125], v[76:77], v[6:7] op_sel_hi:[1,0]
    v_pk_mul_f32 v[126:127], v[78:79], v[6:7] op_sel_hi:[1,0]
    v_pk_fma_f32 v[208:209], v[208:209], v[48:49], v[112:113] neg_lo:[0,0,1] neg_hi:[0,0,1]
    v_pk_fma_f32 v[210:211], v[210:211], v[50:51], v[114:115] neg_lo:[0,0,1] neg_hi:[0,0,1]
    v_pk_fma_f32 v[212:213], v[212:213], v[52:53], v[116:117] neg_lo:[0,0,1] neg_hi:[0,0,1]
    v_pk_fma_f32 v[214:215], v[214:215], v[54:55], v[118:119] neg_lo:[0,0,1] neg_hi:[0,0,1]
    v_pk_fma_f32 v[216:217], v[216:217], v[56:57], v[120:121] neg_lo:[0,0,1] neg_hi:[0,0,1]
    v_pk_fma_f32 v[218:219], v[218:219], v[58:59], v[122:123] neg_lo:[0,0,1] neg_hi:[0,0,1]
    v_pk_fma_f32 v[220:221], v[220:221], v[60:61], v[124:125] neg_lo:[0,0,1] neg_hi:[0,0,1]
    v_pk_fma_f32 v[222:223], v[222:223], v[62:63], v[126:127] neg_lo:[0,0,1] neg_hi:[0,0,1]
    v_cvt_pk_bf16_f32 v34, v208, v209
    v_cvt_pk_bf16_f32 v35, v210, v211
    v_cvt_pk_bf16_f32 v36, v212, v213
    v_cvt_pk_bf16_f32 v37, v214, v215
    v_cvt_pk_bf16_f32 v38, v216, v217
    v_cvt_pk_bf16_f32 v39, v218, v219
    v_cvt_pk_bf16_f32 v40, v220, v221
    v_cvt_pk_bf16_f32 v41, v222, v223
    buffer_store_dwordx4 v[34:37], v17, s[16:19], s40 offen
    buffer_store_dwordx4 v[38:41], v17, s[16:19], s40 offen offset:672
    s_waitcnt lgkmcnt(0)
    v_pk_mul_f32 v[112:113], v[96:97], v[4:5] op_sel_hi:[1,0]
    v_pk_mul_f32 v[114:115], v[98:99], v[4:5] op_sel_hi:[1,0]
    v_pk_mul_f32 v[116:117], v[100:101], v[4:5] op_sel_hi:[1,0]
    v_pk_mul_f32 v[118:119], v[102:103], v[4:5] op_sel_hi:[1,0]
    v_pk_mul_f32 v[120:121], v[104:105], v[4:5] op_sel_hi:[1,0]
    v_pk_mul_f32 v[122:123], v[106:107], v[4:5] op_sel_hi:[1,0]
    v_pk_mul_f32 v[124:125], v[108:109], v[4:5] op_sel_hi:[1,0]
    v_pk_mul_f32 v[126:127], v[110:111], v[4:5] op_sel_hi:[1,0]
    v_pk_fma_f32 v[224:225], v[224:225], v[80:81], v[112:113] neg_lo:[0,0,1] neg_hi:[0,0,1]
    v_pk_fma_f32 v[226:227], v[226:227], v[82:83], v[114:115] neg_lo:[0,0,1] neg_hi:[0,0,1]
    v_pk_fma_f32 v[228:229], v[228:229], v[84:85], v[116:117] neg_lo:[0,0,1] neg_hi:[0,0,1]
    v_pk_fma_f32 v[230:231], v[230:231], v[86:87], v[118:119] neg_lo:[0,0,1] neg_hi:[0,0,1]
    v_pk_fma_f32 v[232:233], v[232:233], v[88:89], v[120:121] neg_lo:[0,0,1] neg_hi:[0,0,1]
    v_pk_fma_f32 v[234:235], v[234:235], v[90:91], v[122:123] neg_lo:[0,0,1] neg_hi:[0,0,1]
    v_pk_fma_f32 v[236:237], v[236:237], v[92:93], v[124:125] neg_lo:[0,0,1] neg_hi:[0,0,1]
    v_pk_fma_f32 v[238:239], v[238:239], v[94:95], v[126:127] neg_lo:[0,0,1] neg_hi:[0,0,1]
    v_cvt_pk_bf16_f32 v18, v224, v225
    v_cvt_pk_bf16_f32 v19, v226, v227
    v_cvt_pk_bf16_f32 v20, v228, v229
    v_cvt_pk_bf16_f32 v21, v230, v231
    v_cvt_pk_bf16_f32 v22, v232, v233
    v_cvt_pk_bf16_f32 v23, v234, v235
    v_cvt_pk_bf16_f32 v24, v236, v237
    v_cvt_pk_bf16_f32 v25, v238, v239
    buffer_store_dwordx4 v[18:21], v16, s[16:19], s41 offen
    buffer_store_dwordx4 v[22:25], v16, s[16:19], s41 offen offset:672
    v_pk_mul_f32 v[112:113], v[96:97], v[6:7] op_sel_hi:[1,0]
    v_pk_mul_f32 v[114:115], v[98:99], v[6:7] op_sel_hi:[1,0]
    v_pk_mul_f32 v[116:117], v[100:101], v[6:7] op_sel_hi:[1,0]
    v_pk_mul_f32 v[118:119], v[102:103], v[6:7] op_sel_hi:[1,0]
    v_pk_mul_f32 v[120:121], v[104:105], v[6:7] op_sel_hi:[1,0]
    v_pk_mul_f32 v[122:123], v[106:107], v[6:7] op_sel_hi:[1,0]
    v_pk_mul_f32 v[124:125], v[108:109], v[6:7] op_sel_hi:[1,0]
    v_pk_mul_f32 v[126:127], v[110:111], v[6:7] op_sel_hi:[1,0]
    v_pk_fma_f32 v[240:241], v[240:241], v[80:81], v[112:113] neg_lo:[0,0,1] neg_hi:[0,0,1]
    v_pk_fma_f32 v[242:243], v[242:243], v[82:83], v[114:115] neg_lo:[0,0,1] neg_hi:[0,0,1]
    v_pk_fma_f32 v[244:245], v[244:245], v[84:85], v[116:117] neg_lo:[0,0,1] neg_hi:[0,0,1]
    v_pk_fma_f32 v[246:247], v[246:247], v[86:87], v[118:119] neg_lo:[0,0,1] neg_hi:[0,0,1]
    v_pk_fma_f32 v[248:249], v[248:249], v[88:89], v[120:121] neg_lo:[0,0,1] neg_hi:[0,0,1]
    v_pk_fma_f32 v[250:251], v[250:251], v[90:91], v[122:123] neg_lo:[0,0,1] neg_hi:[0,0,1]
    v_pk_fma_f32 v[252:253], v[252:253], v[92:93], v[124:125] neg_lo:[0,0,1] neg_hi:[0,0,1]
    v_pk_fma_f32 v[254:255], v[254:255], v[94:95], v[126:127] neg_lo:[0,0,1] neg_hi:[0,0,1]
    v_cvt_pk_bf16_f32 v26, v240, v241
    v_cvt_pk_bf16_f32 v27, v242, v243
    v_cvt_pk_bf16_f32 v28, v244, v245
    v_cvt_pk_bf16_f32 v29, v246, v247
    v_cvt_pk_bf16_f32 v30, v248, v249
    v_cvt_pk_bf16_f32 v31, v250, v251
    v_cvt_pk_bf16_f32 v32, v252, v253
    v_cvt_pk_bf16_f32 v33, v254, v255
    buffer_store_dwordx4 v[26:29], v17, s[16:19], s41 offen
    buffer_store_dwordx4 v[30:33], v17, s[16:19], s41 offen offset:672
    s_endpgm
k1_h:
    s_and_b32 s43, s25, 1
    s_lshr_b32 s44, s25, 1
    v_and_b32 v2, 31, v1
    v_lshrrev_b32 v3, 5, v1
    v_bfe_u32 v4, v2, 1, 3
    s_mul_i32 s45, s43, 8192
    v_lshlrev_b32 v5, 7, v2
    v_add_u32 v5, s45, v5
    v_add_u32 v6, 0, v3
    v_xor_b32 v6, v6, v4
    v_lshl_add_u32 v28, v6, 4, v5
    v_add_u32 v6, 2, v3
    v_xor_b32 v6, v6, v4
    v_lshl_add_u32 v29, v6, 4, v5
    v_add_u32 v6, 4, v3
    v_xor_b32 v6, v6, v4
    v_lshl_add_u32 v30, v6, 4, v5
    v_add_u32 v6, 6, v3
    v_xor_b32 v6, v6, v4
    v_lshl_add_u32 v31, v6, 4, v5
    v_bfe_u32 v6, v1, 2, 2
    v_lshl_add_u32 v7, v3, 3, v6
    v_mul_u32_u24 v7, 384, v7
    v_bfe_u32 v8, v1, 4, 1
    v_lshl_add_u32 v7, v8, 5, v7
    v_and_b32 v8, 3, v1
    v_lshl_add_u32 v7, v8, 3, v7
    v_add_u32 v7, 16384, v7
    v_lshrrev_b32 v6, 1, v6
    s_mul_i32 s46, s44, 3
    s_add_u32 s47, s46, 0
    v_xor_b32 v8, s47, v6
    v_lshl_add_u32 v32, v8, 6, v7
    s_add_u32 s47, s46, 1
    v_xor_b32 v8, s47, v6
    v_lshl_add_u32 v33, v8, 6, v7
    s_add_u32 s47, s46, 2
    v_xor_b32 v8, s47, v6
    v_lshl_add_u32 v34, v8, 6, v7
    v_mov_b32 v128, 0
    v_mov_b32 v129, 0
    v_mov_b32 v130, 0
    v_mov_b32 v131, 0
    v_mov_b32 v132, 0
    v_mov_b32 v133, 0
    v_mov_b32 v134, 0
    v_mov_b32 v135, 0
    v_mov_b32 v136, 0
    v_mov_b32 v137, 0
    v_mov_b32 v138, 0
    v_mov_b32 v139, 0
    v_mov_b32 v140, 0
    v_mov_b32 v141, 0
    v_mov_b32 v142, 0
    v_mov_b32 v143, 0
    v_mov_b32 v144, 0
    v_mov_b32 v145, 0
    v_mov_b32 v146, 0
    v_mov_b32 v147, 0
    v_mov_b32 v148, 0
    v_mov_b32 v149, 0
    v_mov_b32 v150, 0
    v_mov_b32 v151, 0
    v_mov_b32 v152, 0
    v_mov_b32 v153, 0
    v_mov_b32 v154, 0
    v_mov_b32 v155, 0
    v_mov_b32 v156, 0
    v_mov_b32 v157, 0
    v_mov_b32 v158, 0
    v_mov_b32 v159, 0
    v_mov_b32 v160, 0
    v_mov_b32 v161, 0
    v_mov_b32 v162, 0
    v_mov_b32 v163, 0
    v_mov_b32 v164, 0
    v_mov_b32 v165, 0
    v_mov_b32 v166, 0
    v_mov_b32 v167, 0
    v_mov_b32 v168, 0
    v_mov_b32 v169, 0
    v_mov_b32 v170, 0
    v_mov_b32 v171, 0
    v_mov_b32 v172, 0
    v_mov_b32 v173, 0
    v_mov_b32 v174, 0
    v_mov_b32 v175, 0
    v_mov_b32 v176, 0
    v_mov_b32 v177, 0
    v_mov_b32 v178, 0
    v_mov_b32 v179, 0
    v_mov_b32 v180, 0
    v_mov_b32 v181, 0
    v_mov_b32 v182, 0
    v_mov_b32 v183, 0
    v_mov_b32 v184, 0
    v_mov_b32 v185, 0
    v_mov_b32 v186, 0
    v_mov_b32 v187, 0
    v_mov_b32 v188, 0
    v_mov_b32 v189, 0
    v_mov_b32 v190, 0
    v_mov_b32 v191, 0
    v_mov_b32 v192, 0
    v_mov_b32 v193, 0
    v_mov_b32 v194, 0
    v_mov_b32 v195, 0
    v_mov_b32 v196, 0
    v_mov_b32 v197, 0
    v_mov_b32 v198, 0
    v_mov_b32 v199, 0
    v_mov_b32 v200, 0
    v_mov_b32 v201, 0
    v_mov_b32 v202, 0
    v_mov_b32 v203, 0
    v_mov_b32 v204, 0
    v_mov_b32 v205, 0
    v_mov_b32 v206, 0
    v_mov_b32 v207, 0
    v_mov_b32 v208, 0
    v_mov_b32 v209, 0
    v_mov_b32 v210, 0
    v_mov_b32 v211, 0
    v_mov_b32 v212, 0
    v_mov_b32 v213, 0
    v_mov_b32 v214, 0
    v_mov_b32 v215, 0
    v_mov_b32 v216, 0
    v_mov_b32 v217, 0
    v_mov_b32 v218, 0
    v_mov_b32 v219, 0
    v_mov_b32 v220, 0
    v_mov_b32 v221, 0
    v_mov_b32 v222, 0
    v_mov_b32 v223, 0
    s_mov_b32 s24, 0
    s_mov_b32 s20, 0
    v_add_u32 v36, s24, v28
    v_add_u32 v37, s24, v29
    v_add_u32 v38, s24, v30
    v_add_u32 v39, s24, v31
    v_add_u32 v40, s24, v32
    v_add_u32 v41, s24, v33
    v_add_u32 v42, s24, v34
    s_setprio 2
    s_waitcnt lgkmcnt(0)
    s_barrier
    ds_read_b128 v[48:51], v36 offset:0
    ds_read_b128 v[52:55], v36 offset:4096
    ds_read_b64_tr_b16 v[80:81], v40 offset:0
    ds_read_b64_tr_b16 v[82:83], v40 offset:1536
    ds_read_b64_tr_b16 v[84:85], v41 offset:0
    ds_read_b64_tr_b16 v[86:87], v41 offset:1536
    ds_read_b64_tr_b16 v[88:89], v42 offset:0
    ds_read_b64_tr_b16 v[90:91], v42 offset:1536
k1h_loop:
    s_waitcnt lgkmcnt(0)
    v_mfma_f32_32x32x16_bf16 v[128:143], v[80:83], v[48:51], v[128:143]
    ds_read_b128 v[64:67], v37 offset:0
    ds_read_b128 v[68:71], v37 offset:4096
    v_mfma_f32_32x32x16_bf16 v[144:159], v[84:87], v[48:51], v[144:159]
    ds_read_b64_tr_b16 v[92:93], v40 offset:6144
    ds_read_b64_tr_b16 v[94:95], v40 offset:7680
    v_mfma_f32_32x32x16_bf16 v[160:175], v[88:91], v[48:51], v[160:175]
    ds_read_b64_tr_b16 v[96:97], v41 offset:6144
    ds_read_b64_tr_b16 v[98:99], v41 offset:7680
    v_mfma_f32_32x32x16_bf16 v[176:191], v[80:83], v[52:55], v[176:191]
    ds_read_b64_tr_b16 v[100:101], v42 offset:6144
    ds_read_b64_tr_b16 v[102:103], v42 offset:7680
    v_mfma_f32_32x32x16_bf16 v[192:207], v[84:87], v[52:55], v[192:207]
    v_mfma_f32_32x32x16_bf16 v[208:223], v[88:91], v[52:55], v[208:223]
    s_waitcnt lgkmcnt(0)
    v_mfma_f32_32x32x16_bf16 v[128:143], v[92:95], v[64:67], v[128:143]
    ds_read_b128 v[48:51], v38 offset:0
    ds_read_b128 v[52:55], v38 offset:4096
    v_mfma_f32_32x32x16_bf16 v[144:159], v[96:99], v[64:67], v[144:159]
    ds_read_b64_tr_b16 v[80:81], v40 offset:12288
    ds_read_b64_tr_b16 v[82:83], v40 offset:13824
    v_mfma_f32_32x32x16_bf16 v[160:175], v[100:103], v[64:67], v[160:175]
    ds_read_b64_tr_b16 v[84:85], v41 offset:12288
    ds_read_b64_tr_b16 v[86:87], v41 offset:13824
    v_mfma_f32_32x32x16_bf16 v[176:191], v[92:95], v[68:71], v[176:191]
    ds_read_b64_tr_b16 v[88:89], v42 offset:12288
    ds_read_b64_tr_b16 v[90:91], v42 offset:13824
    v_mfma_f32_32x32x16_bf16 v[192:207], v[96:99], v[68:71], v[192:207]
    v_mfma_f32_32x32x16_bf16 v[208:223], v[100:103], v[68:71], v[208:223]
    s_add_u32 s24, s24, 40960
    s_cmp_eq_u32 s24, 122880
    s_cselect_b32 s24, 0, s24
    s_waitcnt lgkmcnt(0)
    v_mfma_f32_32x32x16_bf16 v[128:143], v[80:83], v[48:51], v[128:143]
    ds_read_b128 v[64:67], v39 offset:0
    ds_read_b128 v[68:71], v39 offset:4096
    v_mfma_f32_32x32x16_bf16 v[144:159], v[84:87], v[48:51], v[144:159]
    ds_read_b64_tr_b16 v[92:93], v40 offset:18432
    ds_read_b64_tr_b16 v[94:95], v40 offset:19968
    v_mfma_f32_32x32x16_bf16 v[160:175], v[88:91], v[48:51], v[160:175]
    ds_read_b64_tr_b16 v[96:97], v41 offset:18432
    ds_read_b64_tr_b16 v[98:99], v41 offset:19968
    v_mfma_f32_32x32x16_bf16 v[176:191], v[80:83], v[52:55], v[176:191]
    ds_read_b64_tr_b16 v[100:101], v42 offset:18432
    ds_read_b64_tr_b16 v[102:103], v42 offset:19968
    v_mfma_f32_32x32x16_bf16 v[192:207], v[84:87], v[52:55], v[192:207]
    v_add_u32 v36, s24, v28
    v_add_u32 v37, s24, v29
    v_add_u32 v38, s24, v30
    v_add_u32 v39, s24, v31
    v_mfma_f32_32x32x16_bf16 v[208:223], v[88:91], v[52:55], v[208:223]
    v_add_u32 v40, s24, v32
    v_add_u32 v41, s24, v33
    v_add_u32 v42, s24, v34
    s_waitcnt lgkmcnt(0)
    s_barrier
    v_mfma_f32_32x32x16_bf16 v[128:143], v[92:95], v[64:67], v[128:143]
    ds_read_b128 v[48:51], v36 offset:0
    ds_read_b128 v[52:55], v36 offset:4096
    v_mfma_f32_32x32x16_bf16 v[144:159], v[96:99], v[64:67], v[144:159]
    ds_read_b64_tr_b16 v[80:81], v40 offset:0
    ds_read_b64_tr_b16 v[82:83], v40 offset:1536
    v_mfma_f32_32x32x16_bf16 v[160:175], v[100:103], v[64:67], v[160:175]
    ds_read_b64_tr_b16 v[84:85], v41 offset:0
    ds_read_b64_tr_b16 v[86:87], v41 offset:1536
    v_mfma_f32_32x32x16_bf16 v[176:191], v[92:95], v[68:71], v[176:191]
    ds_read_b64_tr_b16 v[88:89], v42 offset:0
    ds_read_b64_tr_b16 v[90:91], v42 offset:1536
    v_mfma_f32_32x32x16_bf16 v[192:207], v[96:99], v[68:71], v[192:207]
    v_mfma_f32_32x32x16_bf16 v[208:223], v[100:103], v[68:71], v[208:223]
    s_add_u32 s20, s20, 1
    s_cmp_lt_u32 s20, 10
    s_cbranch_scc1 k1h_loop
    s_waitcnt lgkmcnt(0)
    v_and_b32 v2, 31, v1
    v_lshrrev_b32 v3, 5, v1
    s_lshl_b32 s32, s43, 9
    s_add_u32 s32, s32, 147456
    v_lshl_add_u32 v12, v2, 3, s32
    ds_read_b64 v[8:9], v12 offset:0
    ds_read_b64 v[10:11], v12 offset:256
    s_mul_i32 s32, s44, 384
    s_add_u32 s32, s32, 151552
    v_lshl_add_u32 v12, v3, 4, s32
    ds_read_b128 v[48:51], v12 offset:0
    ds_read_b128 v[64:67], v12 offset:768
    ds_read_b128 v[52:55], v12 offset:32
    ds_read_b128 v[68:71], v12 offset:800
    ds_read_b128 v[56:59], v12 offset:64
    ds_read_b128 v[72:75], v12 offset:832
    ds_read_b128 v[60:63], v12 offset:96
    ds_read_b128 v[76:79], v12 offset:864
    s_add_u32 s16, s58, 0x1000000
    s_addc_u32 s17, s59, 0
    s_mov_b32 s18, 0x600000
    s_mov_b32 s19, 0x00020000
    s_lshr_b32 s33, s30, 5
    s_lshl_b32 s32, s43, 1
    s_add_u32 s33, s33, s32
    s_mul_i32 s33, s33, 96
    s_lshr_b32 s32, s31, 4
    s_add_u32 s33, s33, s32
    s_mul_i32 s32, s44, 6
    s_add_u32 s33, s33, s32
    s_lshl_b32 s36, s33, 10
    s_add_u32 s37, s36, 98304
    v_lshlrev_b32 v16, 4, v1
    v_add_u32 v17, 4096, v16
    v_mov_b32 v4, 0xc0135761
    v_mov_b32 v5, 0xbdd2d3e8
    v_mov_b32 v6, 1.0
    s_waitcnt lgkmcnt(0)
    ds_read_b128 v[80:83], v12 offset:128
    ds_read_b128 v[96:99], v12 offset:896
    ds_read_b128 v[84:87], v12 offset:160
    ds_read_b128 v[100:103], v12 offset:928
    ds_read_b128 v[88:91], v12 offset:192
    ds_read_b128 v[104:107], v12 offset:960
    ds_read_b128 v[92:95], v12 offset:224
    ds_read_b128 v[108:111], v12 offset:992
    v_pk_fma_f32 v[112:113], v[48:49], v[8:9], v[64:65] op_sel:[0,1,0] op_sel_hi:[1,1,1] neg_lo:[1,0,0] neg_hi:[1,0,0]
    v_pk_fma_f32 v[114:115], v[50:51], v[8:9], v[66:67] op_sel:[0,1,0] op_sel_hi:[1,1,1] neg_lo:[1,0,0] neg_hi:[1,0,0]
    v_pk_fma_f32 v[116:117], v[52:53], v[8:9], v[68:69] op_sel:[0,1,0] op_sel_hi:[1,1,1] neg_lo:[1,0,0] neg_hi:[1,0,0]
    v_pk_fma_f32 v[118:119], v[54:55], v[8:9], v[70:71] op_sel:[0,1,0] op_sel_hi:[1,1,1] neg_lo:[1,0,0] neg_hi:[1,0,0]
    v_pk_fma_f32 v[120:121], v[56:57], v[8:9], v[72:73] op_sel:[0,1,0] op_sel_hi:[1,1,1] neg_lo:[1,0,0] neg_hi:[1,0,0]
    v_pk_fma_f32 v[122:123], v[58:59], v[8:9], v[74:75] op_sel:[0,1,0] op_sel_hi:[1,1,1] neg_lo:[1,0,0] neg_hi:[1,0,0]
    v_pk_fma_f32 v[124:125], v[60:61], v[8:9], v[76:77] op_sel:[0,1,0] op_sel_hi:[1,1,1] neg_lo:[1,0,0] neg_hi:[1,0,0]
    v_pk_fma_f32 v[126:127], v[62:63], v[8:9], v[78:79] op_sel:[0,1,0] op_sel_hi:[1,1,1] neg_lo:[1,0,0] neg_hi:[1,0,0]
    v_pk_fma_f32 v[128:129], v[128:129], v[8:9], v[112:113] op_sel_hi:[1,0,1]
    v_pk_fma_f32 v[130:131], v[130:131], v[8:9], v[114:115] op_sel_hi:[1,0,1]
    v_pk_fma_f32 v[132:133], v[132:133], v[8:9], v[116:117] op_sel_hi:[1,0,1]
    v_pk_fma_f32 v[134:135], v[134:135], v[8:9], v[118:119] op_sel_hi:[1,0,1]
    v_pk_fma_f32 v[136:137], v[136:137], v[8:9], v[120:121] op_sel_hi:[1,0,1]
    v_pk_fma_f32 v[138:139], v[138:139], v[8:9], v[122:123] op_sel_hi:[1,0,1]
    v_pk_fma_f32 v[140:141], v[140:141], v[8:9], v[124:125] op_sel_hi:[1,0,1]
    v_pk_fma_f32 v[142:143], v[142:143], v[8:9], v[126:127] op_sel_hi:[1,0,1]
    v_pk_mul_f32 v[112:113], v[128:129], v[128:129]
    v_pk_mul_f32 v[114:115], v[130:131], v[130:131]
    v_pk_mul_f32 v[116:117], v[132:133], v[132:133]
    v_pk_mul_f32 v[118:119], v[134:135], v[134:135]
    v_pk_mul_f32 v[120:121], v[136:137], v[136:137]
    v_pk_mul_f32 v[122:123], v[138:139], v[138:139]
    v_pk_mul_f32 v[124:125], v[140:141], v[140:141]
    v_pk_mul_f32 v[126:127], v[142:143], v[142:143]
    v_pk_fma_f32 v[112:113], v[112:113], v[4:5], v[4:5] op_sel:[0,1,0] op_sel_hi:[1,1,0]
    v_pk_fma_f32 v[114:115], v[114:115], v[4:5], v[4:5] op_sel:[0,1,0] op_sel_hi:[1,1,0]
    v_pk_fma_f32 v[116:117], v[116:117], v[4:5], v[4:5] op_sel:[0,1,0] op_sel_hi:[1,1,0]
    v_pk_fma_f32 v[118:119], v[118:119], v[4:5], v[4:5] op_sel:[0,1,0] op_sel_hi:[1,1,0]
    v_pk_fma_f32 v[120:121], v[120:121], v[4:5], v[4:5] op_sel:[0,1,0] op_sel_hi:[1,1,0]
    v_pk_fma_f32 v[122:123], v[122:123], v[4:5], v[4:5] op_sel:[0,1,0] op_sel_hi:[1,1,0]
    v_pk_fma_f32 v[124:125], v[124:125], v[4:5], v[4:5] op_sel:[0,1,0] op_sel_hi:[1,1,0]
    v_pk_fma_f32 v[126:127], v[126:127], v[4:5], v[4:5] op_sel:[0,1,0] op_sel_hi:[1,1,0]
    v_pk_mul_f32 v[112:113], v[112:113], v[128:129]
    v_pk_mul_f32 v[114:115], v[114:115], v[130:131]
    v_pk_mul_f32 v[116:117], v[116:117], v[132:133]
    v_pk_mul_f32 v[118:119], v[118:119], v[134:135]
    v_pk_mul_f32 v[120:121], v[120:121], v[136:137]
    v_pk_mul_f32 v[122:123], v[122:123], v[138:139]
    v_pk_mul_f32 v[124:125], v[124:125], v[140:141]
    v_pk_mul_f32 v[126:127], v[126:127], v[142:143]
    v_exp_f32 v112, v112
    v_exp_f32 v113, v113
    v_exp_f32 v114, v114
    v_exp_f32 v115, v115
    v_exp_f32 v116, v116
    v_exp_f32 v117, v117
    v_exp_f32 v118, v118
    v_exp_f32 v119, v119
    v_exp_f32 v120, v120
    v_exp_f32 v121, v121
    v_exp_f32 v122, v122
    v_exp_f32 v123, v123
    v_exp_f32 v124, v124
    v_exp_f32 v125, v125
    v_exp_f32 v126, v126
    v_exp_f32 v127, v127
    v_pk_add_f32 v[112:113], v[112:113], v[6:7] op_sel_hi:[1,0]
    v_pk_add_f32 v[114:115], v[114:115], v[6:7] op_sel_hi:[1,0]
    v_pk_add_f32 v[116:117], v[116:117], v[6:7] op_sel_hi:[1,0]
    v_pk_add_f32 v[118:119], v[118:119], v[6:7] op_sel_hi:[1,0]
    v_pk_add_f32 v[120:121], v[120:121], v[6:7] op_sel_hi:[1,0]
    v_pk_add_f32 v[122:123], v[122:123], v[6:7] op_sel_hi:[1,0]
    v_pk_add_f32 v[124:125], v[124:125], v[6:7] op_sel_hi:[1,0]
    v_pk_add_f32 v[126:127], v[126:127], v[6:7] op_sel_hi:[1,0]
    v_rcp_f32 v112, v112
    v_rcp_f32 v113, v113
    v_rcp_f32 v114, v114
    v_rcp_f32 v115, v115
    v_rcp_f32 v116, v116
    v_rcp_f32 v117, v117
    v_rcp_f32 v118, v118
    v_rcp_f32 v119, v119
    v_rcp_f32 v120, v120
    v_rcp_f32 v121, v121
    v_rcp_f32 v122, v122
    v_rcp_f32 v123, v123
    v_rcp_f32 v124, v124
    v_rcp_f32 v125, v125
    v_rcp_f32 v126, v126
    v_rcp_f32 v127, v127
    v_pk_mul_f32 v[112:113], v[112:113], v[128:129]
    v_pk_mul_f32 v[114:115], v[114:115], v[130:131]
    v_pk_mul_f32 v[116:117], v[116:117], v[132:133]
    v_pk_mul_f32 v[118:119], v[118:119], v[134:135]
    v_pk_mul_f32 v[120:121], v[120:121], v[136:137]
    v_pk_mul_f32 v[122:123], v[122:123], v[138:139]
    v_pk_mul_f32 v[124:125], v[124:125], v[140:141]
    v_pk_mul_f32 v[126:127], v[126:127], v[142:143]
    v_cvt_pk_bf16_f32 v18, v112, v113
    v_cvt_pk_bf16_f32 v19, v114, v115
    v_cvt_pk_bf16_f32 v20, v116, v117
    v_cvt_pk_bf16_f32 v21, v118, v119
    v_cvt_pk_bf16_f32 v22, v120, v121
    v_cvt_pk_bf16_f32 v23, v122, v123
    v_cvt_pk_bf16_f32 v24, v124, v125
    v_cvt_pk_bf16_f32 v25, v126, v127
    buffer_store_dwordx4 v[18:21], v16, s[16:19], s36 offen offset:0
    buffer_store_dwordx4 v[22:25], v16, s[16:19], s36 offen offset:1024
    v_pk_fma_f32 v[112:113], v[48:49], v[10:11], v[64:65] op_sel:[0,1,0] op_sel_hi:[1,1,1] neg_lo:[1,0,0] neg_hi:[1,0,0]
    v_pk_fma_f32 v[114:115], v[50:51], v[10:11], v[66:67] op_sel:[0,1,0] op_sel_hi:[1,1,1] neg_lo:[1,0,0] neg_hi:[1,0,0]
    v_pk_fma_f32 v[116:117], v[52:53], v[10:11], v[68:69] op_sel:[0,1,0] op_sel_hi:[1,1,1] neg_lo:[1,0,0] neg_hi:[1,0,0]
    v_pk_fma_f32 v[118:119], v[54:55], v[10:11], v[70:71] op_sel:[0,1,0] op_sel_hi:[1,1,1] neg_lo:[1,0,0] neg_hi:[1,0,0]
    v_pk_fma_f32 v[120:121], v[56:57], v[10:11], v[72:73] op_sel:[0,1,0] op_sel_hi:[1,1,1] neg_lo:[1,0,0] neg_hi:[1,0,0]
    v_pk_fma_f32 v[122:123], v[58:59], v[10:11], v[74:75] op_sel:[0,1,0] op_sel_hi:[1,1,1] neg_lo:[1,0,0] neg_hi:[1,0,0]
    v_pk_fma_f32 v[124:125], v[60:61], v[10:11], v[76:77] op_sel:[0,1,0] op_sel_hi:[1,1,1] neg_lo:[1,0,0] neg_hi:[1,0,0]
    v_pk_fma_f32 v[126:127], v[62:63], v[10:11], v[78:79] op_sel:[0,1,0] op_sel_hi:[1,1,1] neg_lo:[1,0,0] neg_hi:[1,0,0]
    v_pk_fma_f32 v[176:177], v[176:177], v[10:11], v[112:113] op_sel_hi:[1,0,1]
    v_pk_fma_f32 v[178:179], v[178:179], v[10:11], v[114:115] op_sel_hi:[1,0,1]
    v_pk_fma_f32 v[180:181], v[180:181], v[10:11], v[116:117] op_sel_hi:[1,0,1]
    v_pk_fma_f32 v[182:183], v[182:183], v[10:11], v[118:119] op_sel_hi:[1,0,1]
    v_pk_fma_f32 v[184:185], v[184:185], v[10:11], v[120:121] op_sel_hi:[1,0,1]
    v_pk_fma_f32 v[186:187], v[186:187], v[10:11], v[122:123] op_sel_hi:[1,0,1]
    v_pk_fma_f32 v[188:189], v[188:189], v[10:11], v[124:125] op_sel_hi:[1,0,1]
    v_pk_fma_f32 v[190:191], v[190:191], v[10:11], v[126:127] op_sel_hi:[1,0,1]
    v_pk_mul_f32 v[112:113], v[176:177], v[176:177]
    v_pk_mul_f32 v[114:115], v[178:179], v[178:179]
    v_pk_mul_f32 v[116:117], v[180:181], v[180:181]
    v_pk_mul_f32 v[118:119], v[182:183], v[182:183]
    v_pk_mul_f32 v[120:121], v[184:185], v[184:185]
    v_pk_mul_f32 v[122:123], v[186:187], v[186:187]
    v_pk_mul_f32 v[124:125], v[188:189], v[188:189]
    v_pk_mul_f32 v[126:127], v[190:191], v[190:191]
    v_pk_fma_f32 v[112:113], v[112:113], v[4:5], v[4:5] op_sel:[0,1,0] op_sel_hi:[1,1,0]
    v_pk_fma_f32 v[114:115], v[114:115], v[4:5], v[4:5] op_sel:[0,1,0] op_sel_hi:[1,1,0]
    v_pk_fma_f32 v[116:117], v[116:117], v[4:5], v[4:5] op_sel:[0,1,0] op_sel_hi:[1,1,0]
    v_pk_fma_f32 v[118:119], v[118:119], v[4:5], v[4:5] op_sel:[0,1,0] op_sel_hi:[1,1,0]
    v_pk_fma_f32 v[120:121], v[120:121], v[4:5], v[4:5] op_sel:[0,1,0] op_sel_hi:[1,1,0]
    v_pk_fma_f32 v[122:123], v[122:123], v[4:5], v[4:5] op_sel:[0,1,0] op_sel_hi:[1,1,0]
    v_pk_fma_f32 v[124:125], v[124:125], v[4:5], v[4:5] op_sel:[0,1,0] op_sel_hi:[1,1,0]
    v_pk_fma_f32 v[126:127], v[126:127], v[4:5], v[4:5] op_sel:[0,1,0] op_sel_hi:[1,1,0]
    v_pk_mul_f32 v[112:113], v[112:113], v[176:177]
    v_pk_mul_f32 v[114:115], v[114:115], v[178:179]
    v_pk_mul_f32 v[116:117], v[116:117], v[180:181]
    v_pk_mul_f32 v[118:119], v[118:119], v[182:183]
    v_pk_mul_f32 v[120:121], v[120:121], v[184:185]
    v_pk_mul_f32 v[122:123], v[122:123], v[186:187]
    v_pk_mul_f32 v[124:125], v[124:125], v[188:189]
    v_pk_mul_f32 v[126:127], v[126:127], v[190:191]
    v_exp_f32 v112, v112
    v_exp_f32 v113, v113
    v_exp_f32 v114, v114
    v_exp_f32 v115, v115
    v_exp_f32 v116, v116
    v_exp_f32 v117, v117
    v_exp_f32 v118, v118
    v_exp_f32 v119, v119
    v_exp_f32 v120, v120
    v_exp_f32 v121, v121
    v_exp_f32 v122, v122
    v_exp_f32 v123, v123
    v_exp_f32 v124, v124
    v_exp_f32 v125, v125
    v_exp_f32 v126, v126
    v_exp_f32 v127, v127
    v_pk_add_f32 v[112:113], v[112:113], v[6:7] op_sel_hi:[1,0]
    v_pk_add_f32 v[114:115], v[114:115], v[6:7] op_sel_hi:[1,0]
    v_pk_add_f32 v[116:117], v[116:117], v[6:7] op_sel_hi:[1,0]
    v_pk_add_f32 v[118:119], v[118:119], v[6:7] op_sel_hi:[1,0]
    v_pk_add_f32 v[120:121], v[120:121], v[6:7] op_sel_hi:[1,0]
    v_pk_add_f32 v[122:123], v[122:123], v[6:7] op_sel_hi:[1,0]
    v_pk_add_f32 v[124:125], v[124:125], v[6:7] op_sel_hi:[1,0]
    v_pk_add_f32 v[126:127], v[126:127], v[6:7] op_sel_hi:[1,0]
    v_rcp_f32 v112, v112
    v_rcp_f32 v113, v113
    v_rcp_f32 v114, v114
    v_rcp_f32 v115, v115
    v_rcp_f32 v116, v116
    v_rcp_f32 v117, v117
    v_rcp_f32 v118, v118
    v_rcp_f32 v119, v119
    v_rcp_f32 v120, v120
    v_rcp_f32 v121, v121
    v_rcp_f32 v122, v122
    v_rcp_f32 v123, v123
    v_rcp_f32 v124, v124
    v_rcp_f32 v125, v125
    v_rcp_f32 v126, v126
    v_rcp_f32 v127, v127
    v_pk_mul_f32 v[112:113], v[112:113], v[176:177]
    v_pk_mul_f32 v[114:115], v[114:115], v[178:179]
    v_pk_mul_f32 v[116:117], v[116:117], v[180:181]
    v_pk_mul_f32 v[118:119], v[118:119], v[182:183]
    v_pk_mul_f32 v[120:121], v[120:121], v[184:185]
    v_pk_mul_f32 v[122:123], v[122:123], v[186:187]
    v_pk_mul_f32 v[124:125], v[124:125], v[188:189]
    v_pk_mul_f32 v[126:127], v[126:127], v[190:191]
    v_cvt_pk_bf16_f32 v26, v112, v113
    v_cvt_pk_bf16_f32 v27, v114, v115
    v_cvt_pk_bf16_f32 v28, v116, v117
    v_cvt_pk_bf16_f32 v29, v118, v119
    v_cvt_pk_bf16_f32 v30, v120, v121
    v_cvt_pk_bf16_f32 v31, v122, v123
    v_cvt_pk_bf16_f32 v32, v124, v125
    v_cvt_pk_bf16_f32 v33, v126, v127
    buffer_store_dwordx4 v[26:29], v16, s[16:19], s37 offen offset:0
    buffer_store_dwordx4 v[30:33], v16, s[16:19], s37 offen offset:1024
    s_waitcnt lgkmcnt(0)
    ds_read_b128 v[48:51], v12 offset:256
    ds_read_b128 v[64:67], v12 offset:1024
    ds_read_b128 v[52:55], v12 offset:288
    ds_read_b128 v[68:71], v12 offset:1056
    ds_read_b128 v[56:59], v12 offset:320
    ds_read_b128 v[72:75], v12 offset:1088
    ds_read_b128 v[60:63], v12 offset:352
    ds_read_b128 v[76:79], v12 offset:1120
    v_pk_fma_f32 v[112:113], v[80:81], v[8:9], v[96:97] op_sel:[0,1,0] op_sel_hi:[1,1,1] neg_lo:[1,0,0] neg_hi:[1,0,0]
    v_pk_fma_f32 v[114:115], v[82:83], v[8:9], v[98:99] op_sel:[0,1,0] op_sel_hi:[1,1,1] neg_lo:[1,0,0] neg_hi:[1,0,0]
    v_pk_fma_f32 v[116:117], v[84:85], v[8:9], v[100:101] op_sel:[0,1,0] op_sel_hi:[1,1,1] neg_lo:[1,0,0] neg_hi:[1,0,0]
    v_pk_fma_f32 v[118:119], v[86:87], v[8:9], v[102:103] op_sel:[0,1,0] op_sel_hi:[1,1,1] neg_lo:[1,0,0] neg_hi:[1,0,0]
    v_pk_fma_f32 v[120:121], v[88:89], v[8:9], v[104:105] op_sel:[0,1,0] op_sel_hi:[1,1,1] neg_lo:[1,0,0] neg_hi:[1,0,0]
    v_pk_fma_f32 v[122:123], v[90:91], v[8:9], v[106:107] op_sel:[0,1,0] op_sel_hi:[1,1,1] neg_lo:[1,0,0] neg_hi:[1,0,0]
    v_pk_fma_f32 v[124:125], v[92:93], v[8:9], v[108:109] op_sel:[0,1,0] op_sel_hi:[1,1,1] neg_lo:[1,0,0] neg_hi:[1,0,0]
    v_pk_fma_f32 v[126:127], v[94:95], v[8:9], v[110:111] op_sel:[0,1,0] op_sel_hi:[1,1,1] neg_lo:[1,0,0] neg_hi:[1,0,0]
    v_pk_fma_f32 v[144:145], v[144:145], v[8:9], v[112:113] op_sel_hi:[1,0,1]
    v_pk_fma_f32 v[146:147], v[146:147], v[8:9], v[114:115] op_sel_hi:[1,0,1]
    v_pk_fma_f32 v[148:149], v[148:149], v[8:9], v[116:117] op_sel_hi:[1,0,1]
    v_pk_fma_f32 v[150:151], v[150:151], v[8:9], v[118:119] op_sel_hi:[1,0,1]
    v_pk_fma_f32 v[152:153], v[152:153], v[8:9], v[120:121] op_sel_hi:[1,0,1]
    v_pk_fma_f32 v[154:155], v[154:155], v[8:9], v[122:123] op_sel_hi:[1,0,1]
    v_pk_fma_f32 v[156:157], v[156:157], v[8:9], v[124:125] op_sel_hi:[1,0,1]
    v_pk_fma_f32 v[158:159], v[158:159], v[8:9], v[126:127] op_sel_hi:[1,0,1]
    v_pk_mul_f32 v[112:113], v[144:145], v[144:145]
    v_pk_mul_f32 v[114:115], v[146:147], v[146:147]
    v_pk_mul_f32 v[116:117], v[148:149], v[148:149]
    v_pk_mul_f32 v[118:119], v[150:151], v[150:151]
    v_pk_mul_f32 v[120:121], v[152:153], v[152:153]
    v_pk_mul_f32 v[122:123], v[154:155], v[154:155]
    v_pk_mul_f32 v[124:125], v[156:157], v[156:157]
    v_pk_mul_f32 v[126:127], v[158:159], v[158:159]
    v_pk_fma_f32 v[112:113], v[112:113], v[4:5], v[4:5] op_sel:[0,1,0] op_sel_hi:[1,1,0]
    v_pk_fma_f32 v[114:115], v[114:115], v[4:5], v[4:5] op_sel:[0,1,0] op_sel_hi:[1,1,0]
    v_pk_fma_f32 v[116:117], v[116:117], v[4:5], v[4:5] op_sel:[0,1,0] op_sel_hi:[1,1,0]
    v_pk_fma_f32 v[118:119], v[118:119], v[4:5], v[4:5] op_sel:[0,1,0] op_sel_hi:[1,1,0]
    v_pk_fma_f32 v[120:121], v[120:121], v[4:5], v[4:5] op_sel:[0,1,0] op_sel_hi:[1,1,0]
    v_pk_fma_f32 v[122:123], v[122:123], v[4:5], v[4:5] op_sel:[0,1,0] op_sel_hi:[1,1,0]
    v_pk_fma_f32 v[124:125], v[124:125], v[4:5], v[4:5] op_sel:[0,1,0] op_sel_hi:[1,1,0]
    v_pk_fma_f32 v[126:127], v[126:127], v[4:5], v[4:5] op_sel:[0,1,0] op_sel_hi:[1,1,0]
    v_pk_mul_f32 v[112:113], v[112:113], v[144:145]
    v_pk_mul_f32 v[114:115], v[114:115], v[146:147]
    v_pk_mul_f32 v[116:117], v[116:117], v[148:149]
    v_pk_mul_f32 v[118:119], v[118:119], v[150:151]
    v_pk_mul_f32 v[120:121], v[120:121], v[152:153]
    v_pk_mul_f32 v[122:123], v[122:123], v[154:155]
    v_pk_mul_f32 v[124:125], v[124:125], v[156:157]
    v_pk_mul_f32 v[126:127], v[126:127], v[158:159]
    v_exp_f32 v112, v112
    v_exp_f32 v113, v113
    v_exp_f32 v114, v114
    v_exp_f32 v115, v115
    v_exp_f32 v116, v116
    v_exp_f32 v117, v117
    v_exp_f32 v118, v118
    v_exp_f32 v119, v119
    v_exp_f32 v120, v120
    v_exp_f32 v121, v121
    v_exp_f32 v122, v122
    v_exp_f32 v123, v123
    v_exp_f32 v124, v124
    v_exp_f32 v125, v125
    v_exp_f32 v126, v126
    v_exp_f32 v127, v127
    v_pk_add_f32 v[112:113], v[112:113], v[6:7] op_sel_hi:[1,0]
    v_pk_add_f32 v[114:115], v[114:115], v[6:7] op_sel_hi:[1,0]
    v_pk_add_f32 v[116:117], v[116:117], v[6:7] op_sel_hi:[1,0]
    v_pk_add_f32 v[118:119], v[118:119], v[6:7] op_sel_hi:[1,0]
    v_pk_add_f32 v[120:121], v[120:121], v[6:7] op_sel_hi:[1,0]
    v_pk_add_f32 v[122:123], v[122:123], v[6:7] op_sel_hi:[1,0]
    v_pk_add_f32 v[124:125], v[124:125], v[6:7] op_sel_hi:[1,0]
    v_pk_add_f32 v[126:127], v[126:127], v[6:7] op_sel_hi:[1,0]
    v_rcp_f32 v112, v112
    v_rcp_f32 v113, v113
    v_rcp_f32 v114, v114
    v_rcp_f32 v115, v115
    v_rcp_f32 v116, v116
    v_rcp_f32 v117, v117
    v_rcp_f32 v118, v118
    v_rcp_f32 v119, v119
    v_rcp_f32 v120, v120
    v_rcp_f32 v121, v121
    v_rcp_f32 v122, v122
    v_rcp_f32 v123, v123
    v_rcp_f32 v124, v124
    v_rcp_f32 v125, v125
    v_rcp_f32 v126, v126
    v_rcp_f32 v127, v127
    v_pk_mul_f32 v[112:113], v[112:113], v[144:145]
    v_pk_mul_f32 v[114:115], v[114:115], v[146:147]
    v_pk_mul_f32 v[116:117], v[116:117], v[148:149]
    v_pk_mul_f32 v[118:119], v[118:119], v[150:151]
    v_pk_mul_f32 v[120:121], v[120:121], v[152:153]
    v_pk_mul_f32 v[122:123], v[122:123], v[154:155]
    v_pk_mul_f32 v[124:125], v[124:125], v[156:157]
    v_pk_mul_f32 v[126:127], v[126:127], v[158:159]
    v_cvt_pk_bf16_f32 v34, v112, v113
    v_cvt_pk_bf16_f32 v35, v114, v115
    v_cvt_pk_bf16_f32 v36, v116, v117
    v_cvt_pk_bf16_f32 v37, v118, v119
    v_cvt_pk_bf16_f32 v38, v120, v121
    v_cvt_pk_bf16_f32 v39, v122, v123
    v_cvt_pk_bf16_f32 v40, v124, v125
    v_cvt_pk_bf16_f32 v41, v126, v127
    buffer_store_dwordx4 v[34:37], v16, s[16:19], s36 offen offset:2048
    buffer_store_dwordx4 v[38:41], v16, s[16:19], s36 offen offset:3072
    v_pk_fma_f32 v[112:113], v[80:81], v[10:11], v[96:97] op_sel:[0,1,0] op_sel_hi:[1,1,1] neg_lo:[1,0,0] neg_hi:[1,0,0]
    v_pk_fma_f32 v[114:115], v[82:83], v[10:11], v[98:99] op_sel:[0,1,0] op_sel_hi:[1,1,1] neg_lo:[1,0,0] neg_hi:[1,0,0]
    v_pk_fma_f32 v[116:117], v[84:85], v[10:11], v[100:101] op_sel:[0,1,0] op_sel_hi:[1,1,1] neg_lo:[1,0,0] neg_hi:[1,0,0]
    v_pk_fma_f32 v[118:119], v[86:87], v[10:11], v[102:103] op_sel:[0,1,0] op_sel_hi:[1,1,1] neg_lo:[1,0,0] neg_hi:[1,0,0]
    v_pk_fma_f32 v[120:121], v[88:89], v[10:11], v[104:105] op_sel:[0,1,0] op_sel_hi:[1,1,1] neg_lo:[1,0,0] neg_hi:[1,0,0]
    v_pk_fma_f32 v[122:123], v[90:91], v[10:11], v[106:107] op_sel:[0,1,0] op_sel_hi:[1,1,1] neg_lo:[1,0,0] neg_hi:[1,0,0]
    v_pk_fma_f32 v[124:125], v[92:93], v[10:11], v[108:109] op_sel:[0,1,0] op_sel_hi:[1,1,1] neg_lo:[1,0,0] neg_hi:[1,0,0]
    v_pk_fma_f32 v[126:127], v[94:95], v[10:11], v[110:111] op_sel:[0,1,0] op_sel_hi:[1,1,1] neg_lo:[1,0,0] neg_hi:[1,0,0]
    v_pk_fma_f32 v[192:193], v[192:193], v[10:11], v[112:113] op_sel_hi:[1,0,1]
    v_pk_fma_f32 v[194:195], v[194:195], v[10:11], v[114:115] op_sel_hi:[1,0,1]
    v_pk_fma_f32 v[196:197], v[196:197], v[10:11], v[116:117] op_sel_hi:[1,0,1]
    v_pk_fma_f32 v[198:199], v[198:199], v[10:11], v[118:119] op_sel_hi:[1,0,1]
    v_pk_fma_f32 v[200:201], v[200:201], v[10:11], v[120:121] op_sel_hi:[1,0,1]
    v_pk_fma_f32 v[202:203], v[202:203], v[10:11], v[122:123] op_sel_hi:[1,0,1]
    v_pk_fma_f32 v[204:205], v[204:205], v[10:11], v[124:125] op_sel_hi:[1,0,1]
    v_pk_fma_f32 v[206:207], v[206:207], v[10:11], v[126:127] op_sel_hi:[1,0,1]
    v_pk_mul_f32 v[112:113], v[192:193], v[192:193]
    v_pk_mul_f32 v[114:115], v[194:195], v[194:195]
    v_pk_mul_f32 v[116:117], v[196:197], v[196:197]
    v_pk_mul_f32 v[118:119], v[198:199], v[198:199]
    v_pk_mul_f32 v[120:121], v[200:201], v[200:201]
    v_pk_mul_f32 v[122:123], v[202:203], v[202:203]
    v_pk_mul_f32 v[124:125], v[204:205], v[204:205]
    v_pk_mul_f32 v[126:127], v[206:207], v[206:207]
    v_pk_fma_f32 v[112:113], v[112:113], v[4:5], v[4:5] op_sel:[0,1,0] op_sel_hi:[1,1,0]
    v_pk_fma_f32 v[114:115], v[114:115], v[4:5], v[4:5] op_sel:[0,1,0] op_sel_hi:[1,1,0]
    v_pk_fma_f32 v[116:117], v[116:117], v[4:5], v[4:5] op_sel:[0,1,0] op_sel_hi:[1,1,0]
    v_pk_fma_f32 v[118:119], v[118:119], v[4:5], v[4:5] op_sel:[0,1,0] op_sel_hi:[1,1,0]
    v_pk_fma_f32 v[120:121], v[120:121], v[4:5], v[4:5] op_sel:[0,1,0] op_sel_hi:[1,1,0]
    v_pk_fma_f32 v[122:123], v[122:123], v[4:5], v[4:5] op_sel:[0,1,0] op_sel_hi:[1,1,0]
    v_pk_fma_f32 v[124:125], v[124:125], v[4:5], v[4:5] op_sel:[0,1,0] op_sel_hi:[1,1,0]
    v_pk_fma_f32 v[126:127], v[126:127], v[4:5], v[4:5] op_sel:[0,1,0] op_sel_hi:[1,1,0]
    v_pk_mul_f32 v[112:113], v[112:113], v[192:193]
    v_pk_mul_f32 v[114:115], v[114:115], v[194:195]
    v_pk_mul_f32 v[116:117], v[116:117], v[196:197]
    v_pk_mul_f32 v[118:119], v[118:119], v[198:199]
    v_pk_mul_f32 v[120:121], v[120:121], v[200:201]
    v_pk_mul_f32 v[122:123], v[122:123], v[202:203]
    v_pk_mul_f32 v[124:125], v[124:125], v[204:205]
    v_pk_mul_f32 v[126:127], v[126:127], v[206:207]
    v_exp_f32 v112, v112
    v_exp_f32 v113, v113
    v_exp_f32 v114, v114
    v_exp_f32 v115, v115
    v_exp_f32 v116, v116
    v_exp_f32 v117, v117
    v_exp_f32 v118, v118
    v_exp_f32 v119, v119
    v_exp_f32 v120, v120
    v_exp_f32 v121, v121
    v_exp_f32 v122, v122
    v_exp_f32 v123, v123
    v_exp_f32 v124, v124
    v_exp_f32 v125, v125
    v_exp_f32 v126, v126
    v_exp_f32 v127, v127
    v_pk_add_f32 v[112:113], v[112:113], v[6:7] op_sel_hi:[1,0]
    v_pk_add_f32 v[114:115], v[114:115], v[6:7] op_sel_hi:[1,0]
    v_pk_add_f32 v[116:117], v[116:117], v[6:7] op_sel_hi:[1,0]
    v_pk_add_f32 v[118:119], v[118:119], v[6:7] op_sel_hi:[1,0]
    v_pk_add_f32 v[120:121], v[120:121], v[6:7] op_sel_hi:[1,0]
    v_pk_add_f32 v[122:123], v[122:123], v[6:7] op_sel_hi:[1,0]
    v_pk_add_f32 v[124:125], v[124:125], v[6:7] op_sel_hi:[1,0]
    v_pk_add_f32 v[126:127], v[126:127], v[6:7] op_sel_hi:[1,0]
    v_rcp_f32 v112, v112
    v_rcp_f32 v113, v113
    v_rcp_f32 v114, v114
    v_rcp_f32 v115, v115
    v_rcp_f32 v116, v116
    v_rcp_f32 v117, v117
    v_rcp_f32 v118, v118
    v_rcp_f32 v119, v119
    v_rcp_f32 v120, v120
    v_rcp_f32 v121, v121
    v_rcp_f32 v122, v122
    v_rcp_f32 v123, v123
    v_rcp_f32 v124, v124
    v_rcp_f32 v125, v125
    v_rcp_f32 v126, v126
    v_rcp_f32 v127, v127
    v_pk_mul_f32 v[112:113], v[112:113], v[192:193]
    v_pk_mul_f32 v[114:115], v[114:115], v[194:195]
    v_pk_mul_f32 v[116:117], v[116:117], v[196:197]
    v_pk_mul_f32 v[118:119], v[118:119], v[198:199]
    v_pk_mul_f32 v[120:121], v[120:121], v[200:201]
    v_pk_mul_f32 v[122:123], v[122:123], v[202:203]
    v_pk_mul_f32 v[124:125], v[124:125], v[204:205]
    v_pk_mul_f32 v[126:127], v[126:127], v[206:207]
    v_cvt_pk_bf16_f32 v18, v112, v113
    v_cvt_pk_bf16_f32 v19, v114, v115
    v_cvt_pk_bf16_f32 v20, v116, v117
    v_cvt_pk_bf16_f32 v21, v118, v119
    v_cvt_pk_bf16_f32 v22, v120, v121
    v_cvt_pk_bf16_f32 v23, v122, v123
    v_cvt_pk_bf16_f32 v24, v124, v125
    v_cvt_pk_bf16_f32 v25, v126, v127
    buffer_store_dwordx4 v[18:21], v16, s[16:19], s37 offen offset:2048
    buffer_store_dwordx4 v[22:25], v16, s[16:19], s37 offen offset:3072
    s_waitcnt lgkmcnt(0)
    v_pk_fma_f32 v[112:113], v[48:49], v[8:9], v[64:65] op_sel:[0,1,0] op_sel_hi:[1,1,1] neg_lo:[1,0,0] neg_hi:[1,0,0]
    v_pk_fma_f32 v[114:115], v[50:51], v[8:9], v[66:67] op_sel:[0,1,0] op_sel_hi:[1,1,1] neg_lo:[1,0,0] neg_hi:[1,0,0]
    v_pk_fma_f32 v[116:117], v[52:53], v[8:9], v[68:69] op_sel:[0,1,0] op_sel_hi:[1,1,1] neg_lo:[1,0,0] neg_hi:[1,0,0]
    v_pk_fma_f32 v[118:119], v[54:55], v[8:9], v[70:71] op_sel:[0,1,0] op_sel_hi:[1,1,1] neg_lo:[1,0,0] neg_hi:[1,0,0]
    v_pk_fma_f32 v[120:121], v[56:57], v[8:9], v[72:73] op_sel:[0,1,0] op_sel_hi:[1,1,1] neg_lo:[1,0,0] neg_hi:[1,0,0]
    v_pk_fma_f32 v[122:123], v[58:59], v[8:9], v[74:75] op_sel:[0,1,0] op_sel_hi:[1,1,1] neg_lo:[1,0,0] neg_hi:[1,0,0]
    v_pk_fma_f32 v[124:125], v[60:61], v[8:9], v[76:77] op_sel:[0,1,0] op_sel_hi:[1,1,1] neg_lo:[1,0,0] neg_hi:[1,0,0]
    v_pk_fma_f32 v[126:127], v[62:63], v[8:9], v[78:79] op_sel:[0,1,0] op_sel_hi:[1,1,1] neg_lo:[1,0,0] neg_hi:[1,0,0]
    v_pk_fma_f32 v[160:161], v[160:161], v[8:9], v[112:113] op_sel_hi:[1,0,1]
    v_pk_fma_f32 v[162:163], v[162:163], v[8:9], v[114:115] op_sel_hi:[1,0,1]
    v_pk_fma_f32 v[164:165], v[164:165], v[8:9], v[116:117] op_sel_hi:[1,0,1]
    v_pk_fma_f32 v[166:167], v[166:167], v[8:9], v[118:119] op_sel_hi:[1,0,1]
    v_pk_fma_f32 v[168:169], v[168:169], v[8:9], v[120:121] op_sel_hi:[1,0,1]
    v_pk_fma_f32 v[170:171], v[170:171], v[8:9], v[122:123] op_sel_hi:[1,0,1]
    v_pk_fma_f32 v[172:173], v[172:173], v[8:9], v[124:125] op_sel_hi:[1,0,1]
    v_pk_fma_f32 v[174:175], v[174:175], v[8:9], v[126:127] op_sel_hi:[1,0,1]
    v_pk_mul_f32 v[112:113], v[160:161], v[160:161]
    v_pk_mul_f32 v[114:115], v[162:163], v[162:163]
    v_pk_mul_f32 v[116:117], v[164:165], v[164:165]
    v_pk_mul_f32 v[118:119], v[166:167], v[166:167]
    v_pk_mul_f32 v[120:121], v[168:169], v[168:169]
    v_pk_mul_f32 v[122:123], v[170:171], v[170:171]
    v_pk_mul_f32 v[124:125], v[172:173], v[172:173]
    v_pk_mul_f32 v[126:127], v[174:175], v[174:175]
    v_pk_fma_f32 v[112:113], v[112:113], v[4:5], v[4:5] op_sel:[0,1,0] op_sel_hi:[1,1,0]
    v_pk_fma_f32 v[114:115], v[114:115], v[4:5], v[4:5] op_sel:[0,1,0] op_sel_hi:[1,1,0]
    v_pk_fma_f32 v[116:117], v[116:117], v[4:5], v[4:5] op_sel:[0,1,0] op_sel_hi:[1,1,0]
    v_pk_fma_f32 v[118:119], v[118:119], v[4:5], v[4:5] op_sel:[0,1,0] op_sel_hi:[1,1,0]
    v_pk_fma_f32 v[120:121], v[120:121], v[4:5], v[4:5] op_sel:[0,1,0] op_sel_hi:[1,1,0]
    v_pk_fma_f32 v[122:123], v[122:123], v[4:5], v[4:5] op_sel:[0,1,0] op_sel_hi:[1,1,0]
    v_pk_fma_f32 v[124:125], v[124:125], v[4:5], v[4:5] op_sel:[0,1,0] op_sel_hi:[1,1,0]
    v_pk_fma_f32 v[126:127], v[126:127], v[4:5], v[4:5] op_sel:[0,1,0] op_sel_hi:[1,1,0]
    v_pk_mul_f32 v[112:113], v[112:113], v[160:161]
    v_pk_mul_f32 v[114:115], v[114:115], v[162:163]
    v_pk_mul_f32 v[116:117], v[116:117], v[164:165]
    v_pk_mul_f32 v[118:119], v[118:119], v[166:167]
    v_pk_mul_f32 v[120:121], v[120:121], v[168:169]
    v_pk_mul_f32 v[122:123], v[122:123], v[170:171]
    v_pk_mul_f32 v[124:125], v[124:125], v[172:173]
    v_pk_mul_f32 v[126:127], v[126:127], v[174:175]
    v_exp_f32 v112, v112
    v_exp_f32 v113, v113
    v_exp_f32 v114, v114
    v_exp_f32 v115, v115
    v_exp_f32 v116, v116
    v_exp_f32 v117, v117
    v_exp_f32 v118, v118
    v_exp_f32 v119, v119
    v_exp_f32 v120, v120
    v_exp_f32 v121, v121
    v_exp_f32 v122, v122
    v_exp_f32 v123, v123
    v_exp_f32 v124, v124
    v_exp_f32 v125, v125
    v_exp_f32 v126, v126
    v_exp_f32 v127, v127
    v_pk_add_f32 v[112:113], v[112:113], v[6:7] op_sel_hi:[1,0]
    v_pk_add_f32 v[114:115], v[114:115], v[6:7] op_sel_hi:[1,0]
    v_pk_add_f32 v[116:117], v[116:117], v[6:7] op_sel_hi:[1,0]
    v_pk_add_f32 v[118:119], v[118:119], v[6:7] op_sel_hi:[1,0]
    v_pk_add_f32 v[120:121], v[120:121], v[6:7] op_sel_hi:[1,0]
    v_pk_add_f32 v[122:123], v[122:123], v[6:7] op_sel_hi:[1,0]
    v_pk_add_f32 v[124:125], v[124:125], v[6:7] op_sel_hi:[1,0]
    v_pk_add_f32 v[126:127], v[126:127], v[6:7] op_sel_hi:[1,0]
    v_rcp_f32 v112, v112
    v_rcp_f32 v113, v113
    v_rcp_f32 v114, v114
    v_rcp_f32 v115, v115
    v_rcp_f32 v116, v116
    v_rcp_f32 v117, v117
    v_rcp_f32 v118, v118
    v_rcp_f32 v119, v119
    v_rcp_f32 v120, v120
    v_rcp_f32 v121, v121
    v_rcp_f32 v122, v122
    v_rcp_f32 v123, v123
    v_rcp_f32 v124, v124
    v_rcp_f32 v125, v125
    v_rcp_f32 v126, v126
    v_rcp_f32 v127, v127
    v_pk_mul_f32 v[112:113], v[112:113], v[160:161]
    v_pk_mul_f32 v[114:115], v[114:115], v[162:163]
    v_pk_mul_f32 v[116:117], v[116:117], v[164:165]
    v_pk_mul_f32 v[118:119], v[118:119], v[166:167]
    v_pk_mul_f32 v[120:121], v[120:121], v[168:169]
    v_pk_mul_f32 v[122:123], v[122:123], v[170:171]
    v_pk_mul_f32 v[124:125], v[124:125], v[172:173]
    v_pk_mul_f32 v[126:127], v[126:127], v[174:175]
    v_cvt_pk_bf16_f32 v26, v112, v113
    v_cvt_pk_bf16_f32 v27, v114, v115
    v_cvt_pk_bf16_f32 v28, v116, v117
    v_cvt_pk_bf16_f32 v29, v118, v119
    v_cvt_pk_bf16_f32 v30, v120, v121
    v_cvt_pk_bf16_f32 v31, v122, v123
    v_cvt_pk_bf16_f32 v32, v124, v125
    v_cvt_pk_bf16_f32 v33, v126, v127
    buffer_store_dwordx4 v[26:29], v17, s[16:19], s36 offen offset:0
    buffer_store_dwordx4 v[30:33], v17, s[16:19], s36 offen offset:1024
    v_pk_fma_f32 v[112:113], v[48:49], v[10:11], v[64:65] op_sel:[0,1,0] op_sel_hi:[1,1,1] neg_lo:[1,0,0] neg_hi:[1,0,0]
    v_pk_fma_f32 v[114:115], v[50:51], v[10:11], v[66:67] op_sel:[0,1,0] op_sel_hi:[1,1,1] neg_lo:[1,0,0] neg_hi:[1,0,0]
    v_pk_fma_f32 v[116:117], v[52:53], v[10:11], v[68:69] op_sel:[0,1,0] op_sel_hi:[1,1,1] neg_lo:[1,0,0] neg_hi:[1,0,0]
    v_pk_fma_f32 v[118:119], v[54:55], v[10:11], v[70:71] op_sel:[0,1,0] op_sel_hi:[1,1,1] neg_lo:[1,0,0] neg_hi:[1,0,0]
    v_pk_fma_f32 v[120:121], v[56:57], v[10:11], v[72:73] op_sel:[0,1,0] op_sel_hi:[1,1,1] neg_lo:[1,0,0] neg_hi:[1,0,0]
    v_pk_fma_f32 v[122:123], v[58:59], v[10:11], v[74:75] op_sel:[0,1,0] op_sel_hi:[1,1,1] neg_lo:[1,0,0] neg_hi:[1,0,0]
    v_pk_fma_f32 v[124:125], v[60:61], v[10:11], v[76:77] op_sel:[0,1,0] op_sel_hi:[1,1,1] neg_lo:[1,0,0] neg_hi:[1,0,0]
    v_pk_fma_f32 v[126:127], v[62:63], v[10:11], v[78:79] op_sel:[0,1,0] op_sel_hi:[1,1,1] neg_lo:[1,0,0] neg_hi:[1,0,0]
    v_pk_fma_f32 v[208:209], v[208:209], v[10:11], v[112:113] op_sel_hi:[1,0,1]
    v_pk_fma_f32 v[210:211], v[210:211], v[10:11], v[114:115] op_sel_hi:[1,0,1]
    v_pk_fma_f32 v[212:213], v[212:213], v[10:11], v[116:117] op_sel_hi:[1,0,1]
    v_pk_fma_f32 v[214:215], v[214:215], v[10:11], v[118:119] op_sel_hi:[1,0,1]
    v_pk_fma_f32 v[216:217], v[216:217], v[10:11], v[120:121] op_sel_hi:[1,0,1]
    v_pk_fma_f32 v[218:219], v[218:219], v[10:11], v[122:123] op_sel_hi:[1,0,1]
    v_pk_fma_f32 v[220:221], v[220:221], v[10:11], v[124:125] op_sel_hi:[1,0,1]
    v_pk_fma_f32 v[222:223], v[222:223], v[10:11], v[126:127] op_sel_hi:[1,0,1]
    v_pk_mul_f32 v[112:113], v[208:209], v[208:209]
    v_pk_mul_f32 v[114:115], v[210:211], v[210:211]
    v_pk_mul_f32 v[116:117], v[212:213], v[212:213]
    v_pk_mul_f32 v[118:119], v[214:215], v[214:215]
    v_pk_mul_f32 v[120:121], v[216:217], v[216:217]
    v_pk_mul_f32 v[122:123], v[218:219], v[218:219]
    v_pk_mul_f32 v[124:125], v[220:221], v[220:221]
    v_pk_mul_f32 v[126:127], v[222:223], v[222:223]
    v_pk_fma_f32 v[112:113], v[112:113], v[4:5], v[4:5] op_sel:[0,1,0] op_sel_hi:[1,1,0]
    v_pk_fma_f32 v[114:115], v[114:115], v[4:5], v[4:5] op_sel:[0,1,0] op_sel_hi:[1,1,0]
    v_pk_fma_f32 v[116:117], v[116:117], v[4:5], v[4:5] op_sel:[0,1,0] op_sel_hi:[1,1,0]
    v_pk_fma_f32 v[118:119], v[118:119], v[4:5], v[4:5] op_sel:[0,1,0] op_sel_hi:[1,1,0]
    v_pk_fma_f32 v[120:121], v[120:121], v[4:5], v[4:5] op_sel:[0,1,0] op_sel_hi:[1,1,0]
    v_pk_fma_f32 v[122:123], v[122:123], v[4:5], v[4:5] op_sel:[0,1,0] op_sel_hi:[1,1,0]
    v_pk_fma_f32 v[124:125], v[124:125], v[4:5], v[4:5] op_sel:[0,1,0] op_sel_hi:[1,1,0]
    v_pk_fma_f32 v[126:127], v[126:127], v[4:5], v[4:5] op_sel:[0,1,0] op_sel_hi:[1,1,0]
    v_pk_mul_f32 v[112:113], v[112:113], v[208:209]
    v_pk_mul_f32 v[114:115], v[114:115], v[210:211]
    v_pk_mul_f32 v[116:117], v[116:117], v[212:213]
    v_pk_mul_f32 v[118:119], v[118:119], v[214:215]
    v_pk_mul_f32 v[120:121], v[120:121], v[216:217]
    v_pk_mul_f32 v[122:123], v[122:123], v[218:219]
    v_pk_mul_f32 v[124:125], v[124:125], v[220:221]
    v_pk_mul_f32 v[126:127], v[126:127], v[222:223]
    v_exp_f32 v112, v112
    v_exp_f32 v113, v113
    v_exp_f32 v114, v114
    v_exp_f32 v115, v115
    v_exp_f32 v116, v116
    v_exp_f32 v117, v117
    v_exp_f32 v118, v118
    v_exp_f32 v119, v119
    v_exp_f32 v120, v120
    v_exp_f32 v121, v121
    v_exp_f32 v122, v122
    v_exp_f32 v123, v123
    v_exp_f32 v124, v124
    v_exp_f32 v125, v125
    v_exp_f32 v126, v126
    v_exp_f32 v127, v127
    v_pk_add_f32 v[112:113], v[112:113], v[6:7] op_sel_hi:[1,0]
    v_pk_add_f32 v[114:115], v[114:115], v[6:7] op_sel_hi:[1,0]
    v_pk_add_f32 v[116:117], v[116:117], v[6:7] op_sel_hi:[1,0]
    v_pk_add_f32 v[118:119], v[118:119], v[6:7] op_sel_hi:[1,0]
    v_pk_add_f32 v[120:121], v[120:121], v[6:7] op_sel_hi:[1,0]
    v_pk_add_f32 v[122:123], v[122:123], v[6:7] op_sel_hi:[1,0]
    v_pk_add_f32 v[124:125], v[124:125], v[6:7] op_sel_hi:[1,0]
    v_pk_add_f32 v[126:127], v[126:127], v[6:7] op_sel_hi:[1,0]
    v_rcp_f32 v112, v112
    v_rcp_f32 v113, v113
    v_rcp_f32 v114, v114
    v_rcp_f32 v115, v115
    v_rcp_f32 v116, v116
    v_rcp_f32 v117, v117
    v_rcp_f32 v118, v118
    v_rcp_f32 v119, v119
    v_rcp_f32 v120, v120
    v_rcp_f32 v121, v121
    v_rcp_f32 v122, v122
    v_rcp_f32 v123, v123
    v_rcp_f32 v124, v124
    v_rcp_f32 v125, v125
    v_rcp_f32 v126, v126
    v_rcp_f32 v127, v127
    v_pk_mul_f32 v[112:113], v[112:113], v[208:209]
    v_pk_mul_f32 v[114:115], v[114:115], v[210:211]
    v_pk_mul_f32 v[116:117], v[116:117], v[212:213]
    v_pk_mul_f32 v[118:119], v[118:119], v[214:215]
    v_pk_mul_f32 v[120:121], v[120:121], v[216:217]
    v_pk_mul_f32 v[122:123], v[122:123], v[218:219]
    v_pk_mul_f32 v[124:125], v[124:125], v[220:221]
    v_pk_mul_f32 v[126:127], v[126:127], v[222:223]
    v_cvt_pk_bf16_f32 v34, v112, v113
    v_cvt_pk_bf16_f32 v35, v114, v115
    v_cvt_pk_bf16_f32 v36, v116, v117
    v_cvt_pk_bf16_f32 v37, v118, v119
    v_cvt_pk_bf16_f32 v38, v120, v121
    v_cvt_pk_bf16_f32 v39, v122, v123
    v_cvt_pk_bf16_f32 v40, v124, v125
    v_cvt_pk_bf16_f32 v41, v126, v127
    buffer_store_dwordx4 v[34:37], v17, s[16:19], s37 offen offset:0
    buffer_store_dwordx4 v[38:41], v17, s[16:19], s37 offen offset:1024
    s_endpgm
k1_helper:
    s_waitcnt lgkmcnt(0)
    s_mov_b32 s8, s4
    s_mov_b32 s9, s5
    s_mov_b32 s10, 0x280000
    s_mov_b32 s11, 0x00020000
    s_mov_b32 s60, s58
    s_mov_b32 s61, s59
    s_mov_b32 s62, 0x30000
    s_mov_b32 s63, 0x00020000
    s_mov_b32 s20, s56
    s_mov_b32 s21, s57
    s_mov_b32 s22, 0x100
    s_mov_b32 s23, 0x00020000
    s_add_u32 s64, s58, 0x2000000
    s_addc_u32 s65, s59, 0
    s_mov_b32 s66, 0x500000
    s_mov_b32 s67, 0x00020000
    s_and_b32 s32, s2, 7
    s_lshr_b32 s33, s2, 3
    s_lshl_b32 s70, s32, 5
    s_add_u32 s70, s70, s33
    s_and_b32 s34, s32, 3
    s_lshr_b32 s35, s32, 2
    s_mul_i32 s35, s35, 27
    s_add_u32 s35, s35, s33
    s_mul_i32 s36, s34, 30
    s_add_u32 s36, s36, s35
    s_mul_i32 s37, s34, 24
    s_add_u32 s37, s37, s35
    s_add_u32 s37, s37, 90
    s_cmp_lt_u32 s35, 30
    s_cselect_b32 s71, s36, s37
    s_cmp_lt_u32 s33, 27
    s_cselect_b32 s71, s71, 255
    v_mov_b32 v240, 0
    v_mov_b32 v241, 153592
    s_cmp_eq_u32 s25, 5
    s_cbranch_scc1 k1_hB
    v_lshrrev_b32 v2, 3, v1
    s_lshl_b32 s32, s70, 3
    v_add_u32 v2, s32, v2
    v_mul_u32_u24 v3, 1280, v2
    v_and_b32 v4, 7, v1
    v_lshl_add_u32 v3, v4, 4, v3
    buffer_load_dwordx4 v[16:19], v3, s[8:11], 0 offen offset:0 nt
    buffer_load_dwordx4 v[20:23], v3, s[8:11], 0 offen offset:128 nt
    buffer_load_dwordx4 v[24:27], v3, s[8:11], 0 offen offset:256 nt
    buffer_load_dwordx4 v[28:31], v3, s[8:11], 0 offen offset:384 nt
    buffer_load_dwordx4 v[32:35], v3, s[8:11], 0 offen offset:512 nt
    buffer_load_dwordx4 v[36:39], v3, s[8:11], 0 offen offset:640 nt
    buffer_load_dwordx4 v[40:43], v3, s[8:11], 0 offen offset:768 nt
    buffer_load_dwordx4 v[44:47], v3, s[8:11], 0 offen offset:896 nt
    buffer_load_dwordx4 v[48:51], v3, s[8:11], 0 offen offset:1024 nt
    buffer_load_dwordx4 v[52:55], v3, s[8:11], 0 offen offset:1152 nt
    s_cmp_lg_u32 s2, 0
    s_cbranch_scc1 k1_hA1
    s_memrealtime s[32:33]
    s_waitcnt lgkmcnt(0)
    s_or_b32 s32, s32, 1
    v_mov_b32 v13, s32
    s_mov_b64 exec, 1
    buffer_store_dword v13, v240, s[20:23], 0 offen sc1
    s_add_u32 s16, s58, 0x80000
    s_addc_u32 s17, s59, 0
    s_mov_b32 s18, 0x40
    s_mov_b32 s19, 0x00020000
    buffer_store_dword v13, v240, s[16:19], 0 offen
    s_mov_b64 exec, -1
k1_hA1:
    s_mov_b32 s16, s50
    s_mov_b32 s17, s51
    s_mov_b32 s18, 0xc00
    s_mov_b32 s19, 0x00020000
    s_cmp_eq_u32 s28, 2
    s_cselect_b32 s18, s18, 0
    v_add_u32 v15, s31, v1
    v_lshlrev_b32 v15, 1, v15
    buffer_load_ushort v232, v15, s[16:19], 0 offen offset:0
    buffer_load_ushort v233, v15, s[16:19], 0 offen offset:128
    buffer_load_ushort v234, v15, s[16:19], 0 offen offset:256
    s_barrier
    s_waitcnt vmcnt(3)
    v_lshlrev_b32 v56, 16, v16
    v_and_b32 v57, 0xffff0000, v16
    v_lshlrev_b32 v58, 16, v17
    v_and_b32 v59, 0xffff0000, v17
    v_lshlrev_b32 v60, 16, v18
    v_and_b32 v61, 0xffff0000, v18
    v_lshlrev_b32 v62, 16, v19
    v_and_b32 v63, 0xffff0000, v19
    v_lshlrev_b32 v64, 16, v20
    v_and_b32 v65, 0xffff0000, v20
    v_lshlrev_b32 v66, 16, v21
    v_and_b32 v67, 0xffff0000, v21
    v_lshlrev_b32 v68, 16, v22
    v_and_b32 v69, 0xffff0000, v22
    v_lshlrev_b32 v70, 16, v23
    v_and_b32 v71, 0xffff0000, v23
    v_lshlrev_b32 v72, 16, v24
    v_and_b32 v73, 0xffff0000, v24
    v_lshlrev_b32 v74, 16, v25
    v_and_b32 v75, 0xffff0000, v25
    v_lshlrev_b32 v76, 16, v26
    v_and_b32 v77, 0xffff0000, v26
    v_lshlrev_b32 v78, 16, v27
    v_and_b32 v79, 0xffff0000, v27
    v_lshlrev_b32 v80, 16, v28
    v_and_b32 v81, 0xffff0000, v28
    v_lshlrev_b32 v82, 16, v29
    v_and_b32 v83, 0xffff0000, v29
    v_lshlrev_b32 v84, 16, v30
    v_and_b32 v85, 0xffff0000, v30
    v_lshlrev_b32 v86, 16, v31
    v_and_b32 v87, 0xffff0000, v31
    v_lshlrev_b32 v88, 16, v32
    v_and_b32 v89, 0xffff0000, v32
    v_lshlrev_b32 v90, 16, v33
    v_and_b32 v91, 0xffff0000, v33
    v_lshlrev_b32 v92, 16, v34
    v_and_b32 v93, 0xffff0000, v34
    v_lshlrev_b32 v94, 16, v35
    v_and_b32 v95, 0xffff0000, v35
    v_add_f32 v5, v56, v57
    v_add_f32 v6, v58, v59
    v_add_f32 v5, v5, v60
    v_add_f32 v6, v6, v61
    v_add_f32 v5, v5, v62
    v_add_f32 v6, v6, v63
    v_add_f32 v5, v5, v64
    v_add_f32 v6, v6, v65
    v_add_f32 v5, v5, v66
    v_add_f32 v6, v6, v67
    v_add_f32 v5, v5, v68
    v_add_f32 v6, v6, v69
    v_add_f32 v5, v5, v70
    v_add_f32 v6, v6, v71
    v_add_f32 v5, v5, v72
    v_add_f32 v6, v6, v73
    v_add_f32 v5, v5, v74
    v_add_f32 v6, v6, v75
    v_add_f32 v5, v5, v76
    v_add_f32 v6, v6, v77
    v_add_f32 v5, v5, v78
    v_add_f32 v6, v6, v79
    v_add_f32 v5, v5, v80
    v_add_f32 v6, v6, v81
    v_add_f32 v5, v5, v82
    v_add_f32 v6, v6, v83
    v_add_f32 v5, v5, v84
    v_add_f32 v6, v6, v85
    v_add_f32 v5, v5, v86
    v_add_f32 v6, v6, v87
    v_add_f32 v5, v5, v88
    v_add_f32 v6, v6, v89
    v_add_f32 v5, v5, v90
    v_add_f32 v6, v6, v91
    v_add_f32 v5, v5, v92
    v_add_f32 v6, v6, v93
    v_add_f32 v5, v5, v94
    v_add_f32 v6, v6, v95
    s_barrier
    buffer_load_dword v242, v240, s[20:23], 0 offen
    v_lshlrev_b32 v96, 16, v36
    v_and_b32 v97, 0xffff0000, v36
    v_lshlrev_b32 v98, 16, v37
    v_and_b32 v99, 0xffff0000, v37
    v_lshlrev_b32 v100, 16, v38
    v_and_b32 v101, 0xffff0000, v38
    v_lshlrev_b32 v102, 16, v39
    v_and_b32 v103, 0xffff0000, v39
    v_lshlrev_b32 v104, 16, v40
    v_and_b32 v105, 0xffff0000, v40
    v_lshlrev_b32 v106, 16, v41
    v_and_b32 v107, 0xffff0000, v41
    v_lshlrev_b32 v108, 16, v42
    v_and_b32 v109, 0xffff0000, v42
    v_lshlrev_b32 v110, 16, v43
    v_and_b32 v111, 0xffff0000, v43
    v_lshlrev_b32 v112, 16, v44
    v_and_b32 v113, 0xffff0000, v44
    v_lshlrev_b32 v114, 16, v45
    v_and_b32 v115, 0xffff0000, v45
    v_lshlrev_b32 v116, 16, v46
    v_and_b32 v117, 0xffff0000, v46
    v_lshlrev_b32 v118, 16, v47
    v_and_b32 v119, 0xffff0000, v47
    v_lshlrev_b32 v120, 16, v48
    v_and_b32 v121, 0xffff0000, v48
    v_lshlrev_b32 v122, 16, v49
    v_and_b32 v123, 0xffff0000, v49
    v_lshlrev_b32 v124, 16, v50
    v_and_b32 v125, 0xffff0000, v50
    v_lshlrev_b32 v126, 16, v51
    v_and_b32 v127, 0xffff0000, v51
    v_lshlrev_b32 v128, 16, v52
    v_and_b32 v129, 0xffff0000, v52
    v_lshlrev_b32 v130, 16, v53
    v_and_b32 v131, 0xffff0000, v53
    v_lshlrev_b32 v132, 16, v54
    v_and_b32 v133, 0xffff0000, v54
    v_lshlrev_b32 v134, 16, v55
    v_and_b32 v135, 0xffff0000, v55
    v_add_f32 v5, v5, v96
    v_add_f32 v6, v6, v97
    v_add_f32 v5, v5, v98
    v_add_f32 v6, v6, v99
    v_add_f32 v5, v5, v100
    v_add_f32 v6, v6, v101
    v_add_f32 v5, v5, v102
    v_add_f32 v6, v6, v103
    v_add_f32 v5, v5, v104
    v_add_f32 v6, v6, v105
    v_add_f32 v5, v5, v106
    v_add_f32 v6, v6, v107
    v_add_f32 v5, v5, v108
    v_add_f32 v6, v6, v109
    v_add_f32 v5, v5, v110
    v_add_f32 v6, v6, v111
    v_add_f32 v5, v5, v112
    v_add_f32 v6, v6, v113
    v_add_f32 v5, v5, v114
    v_add_f32 v6, v6, v115
    v_add_f32 v5, v5, v116
    v_add_f32 v6, v6, v117
    v_add_f32 v5, v5, v118
    v_add_f32 v6, v6, v119
    v_add_f32 v5, v5, v120
    v_add_f32 v6, v6, v121
    v_add_f32 v5, v5, v122
    v_add_f32 v6, v6, v123
    v_add_f32 v5, v5, v124
    v_add_f32 v6, v6, v125
    v_add_f32 v5, v5, v126
    v_add_f32 v6, v6, v127
    v_add_f32 v5, v5, v128
    v_add_f32 v6, v6, v129
    v_add_f32 v5, v5, v130
    v_add_f32 v6, v6, v131
    v_add_f32 v5, v5, v132
    v_add_f32 v6, v6, v133
    v_add_f32 v5, v5, v134
    v_add_f32 v6, v6, v135
    v_add_f32 v5, v5, v6
    s_nop 1
    v_add_f32_dpp v5, v5, v5 quad_perm:[1,0,3,2] row_mask:0xf bank_mask:0xf
    s_nop 1
    v_add_f32_dpp v5, v5, v5 quad_perm:[2,3,0,1] row_mask:0xf bank_mask:0xf
    s_nop 1
    v_add_f32_dpp v5, v5, v5 row_half_mirror row_mask:0xf bank_mask:0xf
    v_mul_f32 v7, 0x3acccccd, v5
    s_barrier
    v_mov_b32 v5, 0
    v_mov_b32 v6, 0
    v_sub_f32 v13, v56, v7
    v_sub_f32 v14, v57, v7
    v_fmac_f32 v5, v13, v13
    v_fmac_f32 v6, v14, v14
    v_sub_f32 v13, v58, v7
    v_sub_f32 v14, v59, v7
    v_fmac_f32 v5, v13, v13
    v_fmac_f32 v6, v14, v14
    v_sub_f32 v13, v60, v7
    v_sub_f32 v14, v61, v7
    v_fmac_f32 v5, v13, v13
    v_fmac_f32 v6, v14, v14
    v_sub_f32 v13, v62, v7
    v_sub_f32 v14, v63, v7
    v_fmac_f32 v5, v13, v13
    v_fmac_f32 v6, v14, v14
    v_sub_f32 v13, v64, v7
    v_sub_f32 v14, v65, v7
    v_fmac_f32 v5, v13, v13
    v_fmac_f32 v6, v14, v14
    v_sub_f32 v13, v66, v7
    v_sub_f32 v14, v67, v7
    v_fmac_f32 v5, v13, v13
    v_fmac_f32 v6, v14, v14
    v_sub_f32 v13, v68, v7
    v_sub_f32 v14, v69, v7
    v_fmac_f32 v5, v13, v13
    v_fmac_f32 v6, v14, v14
    v_sub_f32 v13, v70, v7
    v_sub_f32 v14, v71, v7
    v_fmac_f32 v5, v13, v13
    v_fmac_f32 v6, v14, v14
    v_sub_f32 v13, v72, v7
    v_sub_f32 v14, v73, v7
    v_fmac_f32 v5, v13, v13
    v_fmac_f32 v6, v14, v14
    v_sub_f32 v13, v74, v7
    v_sub_f32 v14, v75, v7
    v_fmac_f32 v5, v13, v13
    v_fmac_f32 v6, v14, v14
    v_sub_f32 v13, v76, v7
    v_sub_f32 v14, v77, v7
    v_fmac_f32 v5, v13, v13
    v_fmac_f32 v6, v14, v14
    v_sub_f32 v13, v78, v7
    v_sub_f32 v14, v79, v7
    v_fmac_f32 v5, v13, v13
    v_fmac_f32 v6, v14, v14
    v_sub_f32 v13, v80, v7
    v_sub_f32 v14, v81, v7
    v_fmac_f32 v5, v13, v13
    v_fmac_f32 v6, v14, v14
    v_sub_f32 v13, v82, v7
    v_sub_f32 v14, v83, v7
    v_fmac_f32 v5, v13, v13
    v_fmac_f32 v6, v14, v14
    v_sub_f32 v13, v84, v7
    v_sub_f32 v14, v85, v7
    v_fmac_f32 v5, v13, v13
    v_fmac_f32 v6, v14, v14
    v_sub_f32 v13, v86, v7
    v_sub_f32 v14, v87, v7
    v_fmac_f32 v5, v13, v13
    v_fmac_f32 v6, v14, v14
    v_sub_f32 v13, v88, v7
    v_sub_f32 v14, v89, v7
    v_fmac_f32 v5, v13, v13
    v_fmac_f32 v6, v14, v14
    v_sub_f32 v13, v90, v7
    v_sub_f32 v14, v91, v7
    v_fmac_f32 v5, v13, v13
    v_fmac_f32 v6, v14, v14
    v_sub_f32 v13, v92, v7
    v_sub_f32 v14, v93, v7
    v_fmac_f32 v5, v13, v13
    v_fmac_f32 v6, v14, v14
    v_sub_f32 v13, v94, v7
    v_sub_f32 v14, v95, v7
    v_fmac_f32 v5, v13, v13
    v_fmac_f32 v6, v14, v14
    v_sub_f32 v13, v96, v7
    v_sub_f32 v14, v97, v7
    v_fmac_f32 v5, v13, v13
    v_fmac_f32 v6, v14, v14
    v_sub_f32 v13, v98, v7
    v_sub_f32 v14, v99, v7
    v_fmac_f32 v5, v13, v13
    v_fmac_f32 v6, v14, v14
    v_sub_f32 v13, v100, v7
    v_sub_f32 v14, v101, v7
    v_fmac_f32 v5, v13, v13
    v_fmac_f32 v6, v14, v14
    v_sub_f32 v13, v102, v7
    v_sub_f32 v14, v103, v7
    v_fmac_f32 v5, v13, v13
    v_fmac_f32 v6, v14, v14
    v_sub_f32 v13, v104, v7
    v_sub_f32 v14, v105, v7
    v_fmac_f32 v5, v13, v13
    v_fmac_f32 v6, v14, v14
    v_sub_f32 v13, v106, v7
    v_sub_f32 v14, v107, v7
    v_fmac_f32 v5, v13, v13
    v_fmac_f32 v6, v14, v14
    s_barrier
    v_sub_f32 v13, v108, v7
    v_sub_f32 v14, v109, v7
    v_fmac_f32 v5, v13, v13
    v_fmac_f32 v6, v14, v14
    v_sub_f32 v13, v110, v7
    v_sub_f32 v14, v111, v7
    v_fmac_f32 v5, v13, v13
    v_fmac_f32 v6, v14, v14
    v_sub_f32 v13, v112, v7
    v_sub_f32 v14, v113, v7
    v_fmac_f32 v5, v13, v13
    v_fmac_f32 v6, v14, v14
    v_sub_f32 v13, v114, v7
    v_sub_f32 v14, v115, v7
    v_fmac_f32 v5, v13, v13
    v_fmac_f32 v6, v14, v14
    v_sub_f32 v13, v116, v7
    v_sub_f32 v14, v117, v7
    v_fmac_f32 v5, v13, v13
    v_fmac_f32 v6, v14, v14
    v_sub_f32 v13, v118, v7
    v_sub_f32 v14, v119, v7
    v_fmac_f32 v5, v13, v13
    v_fmac_f32 v6, v14, v14
    v_sub_f32 v13, v120, v7
    v_sub_f32 v14, v121, v7
    v_fmac_f32 v5, v13, v13
    v_fmac_f32 v6, v14, v14
    v_sub_f32 v13, v122, v7
    v_sub_f32 v14, v123, v7
    v_fmac_f32 v5, v13, v13
    v_fmac_f32 v6, v14, v14
    v_sub_f32 v13, v124, v7
    v_sub_f32 v14, v125, v7
    v_fmac_f32 v5, v13, v13
    v_fmac_f32 v6, v14, v14
    v_sub_f32 v13, v126, v7
    v_sub_f32 v14, v127, v7
    v_fmac_f32 v5, v13, v13
    v_fmac_f32 v6, v14, v14
    v_sub_f32 v13, v128, v7
    v_sub_f32 v14, v129, v7
    v_fmac_f32 v5, v13, v13
    v_fmac_f32 v6, v14, v14
    v_sub_f32 v13, v130, v7
    v_sub_f32 v14, v131, v7
    v_fmac_f32 v5, v13, v13
    v_fmac_f32 v6, v14, v14
    v_sub_f32 v13, v132, v7
    v_sub_f32 v14, v133, v7
    v_fmac_f32 v5, v13, v13
    v_fmac_f32 v6, v14, v14
    v_sub_f32 v13, v134, v7
    v_sub_f32 v14, v135, v7
    v_fmac_f32 v5, v13, v13
    v_fmac_f32 v6, v14, v14
    v_add_f32 v5, v5, v6
    s_nop 1
    v_add_f32_dpp v5, v5, v5 quad_perm:[1,0,3,2] row_mask:0xf bank_mask:0xf
    s_nop 1
    v_add_f32_dpp v5, v5, v5 quad_perm:[2,3,0,1] row_mask:0xf bank_mask:0xf
    s_nop 1
    v_add_f32_dpp v5, v5, v5 row_half_mirror row_mask:0xf bank_mask:0xf
    v_mul_f32 v8, 0x3acccccd, v5
    v_mov_b32 v9, v7
    v_cvt_pk_bf16_f32 v9, v9, v9
    v_and_b32 v9, 0xffff0000, v9
    v_mov_b32 v5, v8
    v_cvt_pk_bf16_f32 v5, v5, v5
    v_and_b32 v5, 0xffff0000, v5
    v_add_f32 v5, 0x3727c5ac, v5
    v_cvt_pk_bf16_f32 v5, v5, v5
    v_and_b32 v5, 0xffff0000, v5
    v_sqrt_f32 v5, v5
    s_nop 0
    v_cvt_pk_bf16_f32 v5, v5, v5
    v_and_b32 v5, 0xffff0000, v5
    v_rcp_f32 v10, v5
    v_sub_f32 v11, v7, v9
    v_mul_f32 v11, v11, v10
    v_cvt_pk_bf16_f32 v11, v11, v11
    v_and_b32 v11, 0xffff0000, v11
    v_mul_f32 v5, v8, v10
    v_mul_f32 v5, v5, v10
    v_cvt_pk_bf16_f32 v5, v5, v5
    v_and_b32 v5, 0xffff0000, v5
    v_add_f32 v5, 0x3727c5ac, v5
    v_cvt_pk_bf16_f32 v5, v5, v5
    v_and_b32 v5, 0xffff0000, v5
    v_sqrt_f32 v5, v5
    s_nop 0
    v_cvt_pk_bf16_f32 v5, v5, v5
    v_and_b32 v5, 0xffff0000, v5
    v_rcp_f32 v12, v5
    v_mov_b32 v16, v10
    v_mul_f32 v17, v9, v10
    v_mul_f32 v20, v10, v12
    v_add_f32 v21, v17, v11
    v_mul_f32 v21, v21, v12
    s_mov_b32 s34, 0
k1_hn:
    s_waitcnt vmcnt(0)
    v_readfirstlane_b32 s76, v242
    s_nop 3
    s_cmp_lg_u32 s76, 0
    s_cbranch_scc1 k1_hn_ok
    buffer_load_dword v242, v240, s[20:23], 0 offen sc1
    s_add_u32 s34, s34, 1
    s_sleep 1
    s_cmp_lt_u32 s34, 400
    s_cbranch_scc1 k1_hn
k1_hn_ok:
    v_mov_b32 v242, s76
    ds_write_b32 v241, v242
    v_mov_b32 v18, s76
    v_mov_b32 v19, s76
    v_mov_b32 v22, s76
    v_mov_b32 v23, s76
    v_lshlrev_b32 v3, 4, v2
    v_add_u32 v4, 0x8000, v3
    s_mov_b32 exec_lo, 0x01010101
    s_mov_b32 exec_hi, 0x01010101
    buffer_store_dwordx4 v[16:19], v3, s[60:63], 0 offen sc1
    buffer_store_dwordx4 v[20:23], v4, s[60:63], 0 offen sc1
    s_mov_b64 exec, -1
    s_waitcnt lgkmcnt(0)
    s_barrier
    s_cmp_eq_u32 s28, 3
    s_cbranch_scc1 k1_done
    s_barrier
    s_barrier
    s_barrier
    v_add_u32 v243, s30, v1
    v_lshlrev_b32 v243, 4, v243
    s_cmp_eq_u32 s28, 2
    s_cselect_b32 s32, 0x8000, 0
    v_add_u32 v243, s32, v243
    v_add_u32 v244, s29, v1
    v_lshlrev_b32 v244, 3, v244
    v_add_u32 v244, 65536, v244
    s_mov_b32 s68, 0
    s_mov_b32 s69, 0x8000
    s_mov_b32 s74, 0x10000
    s_mov_b32 s75, 0x18000
    buffer_load_dwordx4 v[16:19], v243, s[60:63], 0 offen offset:0 sc1
    buffer_load_dwordx4 v[20:23], v243, s[60:63], 0 offen offset:1024 sc1
    buffer_load_dwordx4 v[24:27], v243, s[60:63], 0 offen offset:2048 sc1
    buffer_load_dwordx4 v[28:31], v243, s[60:63], 0 offen offset:3072 sc1
    buffer_load_dwordx2 v[32:33], v244, s[60:63], s68 offen offset:0 sc1
    buffer_load_dwordx2 v[34:35], v244, s[60:63], s68 offen offset:512 sc1
    buffer_load_dwordx2 v[36:37], v244, s[60:63], s68 offen offset:1024 sc1
    buffer_load_dwordx2 v[38:39], v244, s[60:63], s69 offen offset:0 sc1
    buffer_load_dwordx2 v[40:41], v244, s[60:63], s69 offen offset:512 sc1
    buffer_load_dwordx2 v[42:43], v244, s[60:63], s69 offen offset:1024 sc1
    buffer_load_dwordx2 v[44:45], v244, s[60:63], s74 offen offset:0 sc1
    buffer_load_dwordx2 v[46:47], v244, s[60:63], s74 offen offset:512 sc1
    buffer_load_dwordx2 v[48:49], v244, s[60:63], s74 offen offset:1024 sc1
    buffer_load_dwordx2 v[50:51], v244, s[60:63], s75 offen offset:0 sc1
    buffer_load_dwordx2 v[52:53], v244, s[60:63], s75 offen offset:512 sc1
    buffer_load_dwordx2 v[54:55], v244, s[60:63], s75 offen offset:1024 sc1
    s_barrier
    s_barrier
    s_mov_b32 s34, 0
    s_mov_b32 s38, 1
k1_hpoll:
    s_waitcnt vmcnt(0)
    v_xor_b32 v60, s76, v18
    v_xor_b32 v61, s76, v22
    v_or_b32 v60, v60, v61
    v_xor_b32 v61, s76, v33
    v_or_b32 v60, v60, v61
    v_xor_b32 v61, s76, v35
    v_or_b32 v60, v60, v61
    v_xor_b32 v61, s76, v39
    v_or_b32 v60, v60, v61
    v_xor_b32 v61, s76, v41
    v_or_b32 v60, v60, v61
    v_xor_b32 v61, s76, v45
    v_or_b32 v60, v60, v61
    v_xor_b32 v61, s76, v47
    v_or_b32 v60, v60, v61
    v_xor_b32 v61, s76, v51
    v_or_b32 v60, v60, v61
    v_xor_b32 v61, s76, v53
    v_or_b32 v60, v60, v61
    v_xor_b32 v62, s76, v26
    v_xor_b32 v61, s76, v30
    v_or_b32 v62, v62, v61
    v_xor_b32 v63, s76, v37
    v_xor_b32 v61, s76, v43
    v_or_b32 v63, v63, v61
    v_xor_b32 v61, s76, v49
    v_or_b32 v63, v63, v61
    v_xor_b32 v61, s76, v55
    v_or_b32 v63, v63, v61
    v_cmp_ne_u32 s[40:41], 0, v60
    v_cmp_ne_u32 s[42:43], 0, v62
    v_cmp_ne_u32 s[46:47], 0, v63
    s_nop 3
    s_cmp_eq_u32 s28, 2
    s_cselect_b64 s[42:43], s[46:47], s[42:43]
    s_or_b64 s[40:41], s[40:41], s[42:43]
    s_cselect_b32 s32, 1, 0
    s_cmp_eq_u32 s76, 0
    s_cselect_b32 s32, 1, s32
    s_cmp_eq_u32 s32, 0
    s_cbranch_scc1 k1_hok
    s_cmp_eq_u32 s38, 0
    s_cbranch_scc0 k1_hp2
    s_mov_b32 s38, 1
    s_barrier
k1_hp2:
    s_sleep 2
    buffer_load_dwordx4 v[16:19], v243, s[60:63], 0 offen offset:0 sc1
    buffer_load_dwordx4 v[20:23], v243, s[60:63], 0 offen offset:1024 sc1
    buffer_load_dwordx4 v[24:27], v243, s[60:63], 0 offen offset:2048 sc1
    buffer_load_dwordx4 v[28:31], v243, s[60:63], 0 offen offset:3072 sc1
    buffer_load_dwordx2 v[32:33], v244, s[60:63], s68 offen offset:0 sc1
    buffer_load_dwordx2 v[34:35], v244, s[60:63], s68 offen offset:512 sc1
    buffer_load_dwordx2 v[36:37], v244, s[60:63], s68 offen offset:1024 sc1
    buffer_load_dwordx2 v[38:39], v244, s[60:63], s69 offen offset:0 sc1
    buffer_load_dwordx2 v[40:41], v244, s[60:63], s69 offen offset:512 sc1
    buffer_load_dwordx2 v[42:43], v244, s[60:63], s69 offen offset:1024 sc1
    buffer_load_dwordx2 v[44:45], v244, s[60:63], s74 offen offset:0 sc1
    buffer_load_dwordx2 v[46:47], v244, s[60:63], s74 offen offset:512 sc1
    buffer_load_dwordx2 v[48:49], v244, s[60:63], s74 offen offset:1024 sc1
    buffer_load_dwordx2 v[50:51], v244, s[60:63], s75 offen offset:0 sc1
    buffer_load_dwordx2 v[52:53], v244, s[60:63], s75 offen offset:512 sc1
    buffer_load_dwordx2 v[54:55], v244, s[60:63], s75 offen offset:1024 sc1
    s_add_u32 s34, s34, 1
    s_cmp_eq_u32 s76, 0
    s_cbranch_scc1 k1_hself
    s_cmp_lt_u32 s34, 400
    s_cbranch_scc1 k1_hpoll
k1_hself:
    s_lshl_b32 s32, s2, 18
    s_add_u32 s32, s32, 134217728
    s_add_u32 s60, s58, s32
    s_addc_u32 s61, s59, 0
    s_lshr_b32 s70, s30, 3
    s_lshr_b32 s39, s27, 3
    s_add_u32 s39, s39, s70
k1_hs1:
    v_lshrrev_b32 v2, 3, v1
    s_lshl_b32 s32, s70, 3
    v_add_u32 v2, s32, v2
    v_mul_u32_u24 v3, 1280, v2
    v_and_b32 v4, 7, v1
    v_lshl_add_u32 v3, v4, 4, v3
    buffer_load_dwordx4 v[16:19], v3, s[8:11], 0 offen offset:0 nt
    buffer_load_dwordx4 v[20:23], v3, s[8:11], 0 offen offset:128 nt
    buffer_load_dwordx4 v[24:27], v3, s[8:11], 0 offen offset:256 nt
    buffer_load_dwordx4 v[28:31], v3, s[8:11], 0 offen offset:384 nt
    buffer_load_dwordx4 v[32:35], v3, s[8:11], 0 offen offset:512 nt
    buffer_load_dwordx4 v[36:39], v3, s[8:11], 0 offen offset:640 nt
    buffer_load_dwordx4 v[40:43], v3, s[8:11], 0 offen offset:768 nt
    buffer_load_dwordx4 v[44:47], v3, s[8:11], 0 offen offset:896 nt
    buffer_load_dwordx4 v[48:51], v3, s[8:11], 0 offen offset:1024 nt
    buffer_load_dwordx4 v[52:55], v3, s[8:11], 0 offen offset:1152 nt
    s_waitcnt vmcnt(0)
    v_lshlrev_b32 v56, 16, v16
    v_and_b32 v57, 0xffff0000, v16
    v_lshlrev_b32 v58, 16, v17
    v_and_b32 v59, 0xffff0000, v17
    v_lshlrev_b32 v60, 16, v18
    v_and_b32 v61, 0xffff0000, v18
    v_lshlrev_b32 v62, 16, v19
    v_and_b32 v63, 0xffff0000, v19
    v_lshlrev_b32 v64, 16, v20
    v_and_b32 v65, 0xffff0000, v20
    v_lshlrev_b32 v66, 16, v21
    v_and_b32 v67, 0xffff0000, v21
    v_lshlrev_b32 v68, 16, v22
    v_and_b32 v69, 0xffff0000, v22
    v_lshlrev_b32 v70, 16, v23
    v_and_b32 v71, 0xffff0000, v23
    v_lshlrev_b32 v72, 16, v24
    v_and_b32 v73, 0xffff0000, v24
    v_lshlrev_b32 v74, 16, v25
    v_and_b32 v75, 0xffff0000, v25
    v_lshlrev_b32 v76, 16, v26
    v_and_b32 v77, 0xffff0000, v26
    v_lshlrev_b32 v78, 16, v27
    v_and_b32 v79, 0xffff0000, v27
    v_lshlrev_b32 v80, 16, v28
    v_and_b32 v81, 0xffff0000, v28
    v_lshlrev_b32 v82, 16, v29
    v_and_b32 v83, 0xffff0000, v29
    v_lshlrev_b32 v84, 16, v30
    v_and_b32 v85, 0xffff0000, v30
    v_lshlrev_b32 v86, 16, v31
    v_and_b32 v87, 0xffff0000, v31
    v_lshlrev_b32 v88, 16, v32
    v_and_b32 v89, 0xffff0000, v32
    v_lshlrev_b32 v90, 16, v33
    v_and_b32 v91, 0xffff0000, v33
    v_lshlrev_b32 v92, 16, v34
    v_and_b32 v93, 0xffff0000, v34
    v_lshlrev_b32 v94, 16, v35
    v_and_b32 v95, 0xffff0000, v35
    v_add_f32 v5, v56, v57
    v_add_f32 v6, v58, v59
    v_add_f32 v5, v5, v60
    v_add_f32 v6, v6, v61
    v_add_f32 v5, v5, v62
    v_add_f32 v6, v6, v63
    v_add_f32 v5, v5, v64
    v_add_f32 v6, v6, v65
    v_add_f32 v5, v5, v66
    v_add_f32 v6, v6, v67
    v_add_f32 v5, v5, v68
    v_add_f32 v6, v6, v69
    v_add_f32 v5, v5, v70
    v_add_f32 v6, v6, v71
    v_add_f32 v5, v5, v72
    v_add_f32 v6, v6, v73
    v_add_f32 v5, v5, v74
    v_add_f32 v6, v6, v75
    v_add_f32 v5, v5, v76
    v_add_f32 v6, v6, v77
    v_add_f32 v5, v5, v78
    v_add_f32 v6, v6, v79
    v_add_f32 v5, v5, v80
    v_add_f32 v6, v6, v81
    v_add_f32 v5, v5, v82
    v_add_f32 v6, v6, v83
    v_add_f32 v5, v5, v84
    v_add_f32 v6, v6, v85
    v_add_f32 v5, v5, v86
    v_add_f32 v6, v6, v87
    v_add_f32 v5, v5, v88
    v_add_f32 v6, v6, v89
    v_add_f32 v5, v5, v90
    v_add_f32 v6, v6, v91
    v_add_f32 v5, v5, v92
    v_add_f32 v6, v6, v93
    v_add_f32 v5, v5, v94
    v_add_f32 v6, v6, v95
    v_lshlrev_b32 v96, 16, v36
    v_and_b32 v97, 0xffff0000, v36
    v_lshlrev_b32 v98, 16, v37
    v_and_b32 v99, 0xffff0000, v37
    v_lshlrev_b32 v100, 16, v38
    v_and_b32 v101, 0xffff0000, v38
    v_lshlrev_b32 v102, 16, v39
    v_and_b32 v103, 0xffff0000, v39
    v_lshlrev_b32 v104, 16, v40
    v_and_b32 v105, 0xffff0000, v40
    v_lshlrev_b32 v106, 16, v41
    v_and_b32 v107, 0xffff0000, v41
    v_lshlrev_b32 v108, 16, v42
    v_and_b32 v109, 0xffff0000, v42
    v_lshlrev_b32 v110, 16, v43
    v_and_b32 v111, 0xffff0000, v43
    v_lshlrev_b32 v112, 16, v44
    v_and_b32 v113, 0xffff0000, v44
    v_lshlrev_b32 v114, 16, v45
    v_and_b32 v115, 0xffff0000, v45
    v_lshlrev_b32 v116, 16, v46
    v_and_b32 v117, 0xffff0000, v46
    v_lshlrev_b32 v118, 16, v47
    v_and_b32 v119, 0xffff0000, v47
    v_lshlrev_b32 v120, 16, v48
    v_and_b32 v121, 0xffff0000, v48
    v_lshlrev_b32 v122, 16, v49
    v_and_b32 v123, 0xffff0000, v49
    v_lshlrev_b32 v124, 16, v50
    v_and_b32 v125, 0xffff0000, v50
    v_lshlrev_b32 v126, 16, v51
    v_and_b32 v127, 0xffff0000, v51
    v_lshlrev_b32 v128, 16, v52
    v_and_b32 v129, 0xffff0000, v52
    v_lshlrev_b32 v130, 16, v53
    v_and_b32 v131, 0xffff0000, v53
    v_lshlrev_b32 v132, 16, v54
    v_and_b32 v133, 0xffff0000, v54
    v_lshlrev_b32 v134, 16, v55
    v_and_b32 v135, 0xffff0000, v55
    v_add_f32 v5, v5, v96
    v_add_f32 v6, v6, v97
    v_add_f32 v5, v5, v98
    v_add_f32 v6, v6, v99
    v_add_f32 v5, v5, v100
    v_add_f32 v6, v6, v101
    v_add_f32 v5, v5, v102
    v_add_f32 v6, v6, v103
    v_add_f32 v5, v5, v104
    v_add_f32 v6, v6, v105
    v_add_f32 v5, v5, v106
    v_add_f32 v6, v6, v107
    v_add_f32 v5, v5, v108
    v_add_f32 v6, v6, v109
    v_add_f32 v5, v5, v110
    v_add_f32 v6, v6, v111
    v_add_f32 v5, v5, v112
    v_add_f32 v6, v6, v113
    v_add_f32 v5, v5, v114
    v_add_f32 v6, v6, v115
    v_add_f32 v5, v5, v116
    v_add_f32 v6, v6, v117
    v_add_f32 v5, v5, v118
    v_add_f32 v6, v6, v119
    v_add_f32 v5, v5, v120
    v_add_f32 v6, v6, v121
    v_add_f32 v5, v5, v122
    v_add_f32 v6, v6, v123
    v_add_f32 v5, v5, v124
    v_add_f32 v6, v6, v125
    v_add_f32 v5, v5, v126
    v_add_f32 v6, v6, v127
    v_add_f32 v5, v5, v128
    v_add_f32 v6, v6, v129
    v_add_f32 v5, v5, v130
    v_add_f32 v6, v6, v131
    v_add_f32 v5, v5, v132
    v_add_f32 v6, v6, v133
    v_add_f32 v5, v5, v134
    v_add_f32 v6, v6, v135
    v_add_f32 v5, v5, v6
    s_nop 1
    v_add_f32_dpp v5, v5, v5 quad_perm:[1,0,3,2] row_mask:0xf bank_mask:0xf
    s_nop 1
    v_add_f32_dpp v5, v5, v5 quad_perm:[2,3,0,1] row_mask:0xf bank_mask:0xf
    s_nop 1
    v_add_f32_dpp v5, v5, v5 row_half_mirror row_mask:0xf bank_mask:0xf
    v_mul_f32 v7, 0x3acccccd, v5
    v_mov_b32 v5, 0
    v_mov_b32 v6, 0
    v_sub_f32 v13, v56, v7
    v_sub_f32 v14, v57, v7
    v_fmac_f32 v5, v13, v13
    v_fmac_f32 v6, v14, v14
    v_sub_f32 v13, v58, v7
    v_sub_f32 v14, v59, v7
    v_fmac_f32 v5, v13, v13
    v_fmac_f32 v6, v14, v14
    v_sub_f32 v13, v60, v7
    v_sub_f32 v14, v61, v7
    v_fmac_f32 v5, v13, v13
    v_fmac_f32 v6, v14, v14
    v_sub_f32 v13, v62, v7
    v_sub_f32 v14, v63, v7
    v_fmac_f32 v5, v13, v13
    v_fmac_f32 v6, v14, v14
    v_sub_f32 v13, v64, v7
    v_sub_f32 v14, v65, v7
    v_fmac_f32 v5, v13, v13
    v_fmac_f32 v6, v14, v14
    v_sub_f32 v13, v66, v7
    v_sub_f32 v14, v67, v7
    v_fmac_f32 v5, v13, v13
    v_fmac_f32 v6, v14, v14
    v_sub_f32 v13, v68, v7
    v_sub_f32 v14, v69, v7
    v_fmac_f32 v5, v13, v13
    v_fmac_f32 v6, v14, v14
    v_sub_f32 v13, v70, v7
    v_sub_f32 v14, v71, v7
    v_fmac_f32 v5, v13, v13
    v_fmac_f32 v6, v14, v14
    v_sub_f32 v13, v72, v7
    v_sub_f32 v14, v73, v7
    v_fmac_f32 v5, v13, v13
    v_fmac_f32 v6, v14, v14
    v_sub_f32 v13, v74, v7
    v_sub_f32 v14, v75, v7
    v_fmac_f32 v5, v13, v13
    v_fmac_f32 v6, v14, v14
    v_sub_f32 v13, v76, v7
    v_sub_f32 v14, v77, v7
    v_fmac_f32 v5, v13, v13
    v_fmac_f32 v6, v14, v14
    v_sub_f32 v13, v78, v7
    v_sub_f32 v14, v79, v7
    v_fmac_f32 v5, v13, v13
    v_fmac_f32 v6, v14, v14
    v_sub_f32 v13, v80, v7
    v_sub_f32 v14, v81, v7
    v_fmac_f32 v5, v13, v13
    v_fmac_f32 v6, v14, v14
    v_sub_f32 v13, v82, v7
    v_sub_f32 v14, v83, v7
    v_fmac_f32 v5, v13, v13
    v_fmac_f32 v6, v14, v14
    v_sub_f32 v13, v84, v7
    v_sub_f32 v14, v85, v7
    v_fmac_f32 v5, v13, v13
    v_fmac_f32 v6, v14, v14
    v_sub_f32 v13, v86, v7
    v_sub_f32 v14, v87, v7
    v_fmac_f32 v5, v13, v13
    v_fmac_f32 v6, v14, v14
    v_sub_f32 v13, v88, v7
    v_sub_f32 v14, v89, v7
    v_fmac_f32 v5, v13, v13
    v_fmac_f32 v6, v14, v14
    v_sub_f32 v13, v90, v7
    v_sub_f32 v14, v91, v7
    v_fmac_f32 v5, v13, v13
    v_fmac_f32 v6, v14, v14
    v_sub_f32 v13, v92, v7
    v_sub_f32 v14, v93, v7
    v_fmac_f32 v5, v13, v13
    v_fmac_f32 v6, v14, v14
    v_sub_f32 v13, v94, v7
    v_sub_f32 v14, v95, v7
    v_fmac_f32 v5, v13, v13
    v_fmac_f32 v6, v14, v14
    v_sub_f32 v13, v96, v7
    v_sub_f32 v14, v97, v7
    v_fmac_f32 v5, v13, v13
    v_fmac_f32 v6, v14, v14
    v_sub_f32 v13, v98, v7
    v_sub_f32 v14, v99, v7
    v_fmac_f32 v5, v13, v13
    v_fmac_f32 v6, v14, v14
    v_sub_f32 v13, v100, v7
    v_sub_f32 v14, v101, v7
    v_fmac_f32 v5, v13, v13
    v_fmac_f32 v6, v14, v14
    v_sub_f32 v13, v102, v7
    v_sub_f32 v14, v103, v7
    v_fmac_f32 v5, v13, v13
    v_fmac_f32 v6, v14, v14
    v_sub_f32 v13, v104, v7
    v_sub_f32 v14, v105, v7
    v_fmac_f32 v5, v13, v13
    v_fmac_f32 v6, v14, v14
    v_sub_f32 v13, v106, v7
    v_sub_f32 v14, v107, v7
    v_fmac_f32 v5, v13, v13
    v_fmac_f32 v6, v14, v14
    v_sub_f32 v13, v108, v7
    v_sub_f32 v14, v109, v7
    v_fmac_f32 v5, v13, v13
    v_fmac_f32 v6, v14, v14
    v_sub_f32 v13, v110, v7
    v_sub_f32 v14, v111, v7
    v_fmac_f32 v5, v13, v13
    v_fmac_f32 v6, v14, v14
    v_sub_f32 v13, v112, v7
    v_sub_f32 v14, v113, v7
    v_fmac_f32 v5, v13, v13
    v_fmac_f32 v6, v14, v14
    v_sub_f32 v13, v114, v7
    v_sub_f32 v14, v115, v7
    v_fmac_f32 v5, v13, v13
    v_fmac_f32 v6, v14, v14
    v_sub_f32 v13, v116, v7
    v_sub_f32 v14, v117, v7
    v_fmac_f32 v5, v13, v13
    v_fmac_f32 v6, v14, v14
    v_sub_f32 v13, v118, v7
    v_sub_f32 v14, v119, v7
    v_fmac_f32 v5, v13, v13
    v_fmac_f32 v6, v14, v14
    v_sub_f32 v13, v120, v7
    v_sub_f32 v14, v121, v7
    v_fmac_f32 v5, v13, v13
    v_fmac_f32 v6, v14, v14
    v_sub_f32 v13, v122, v7
    v_sub_f32 v14, v123, v7
    v_fmac_f32 v5, v13, v13
    v_fmac_f32 v6, v14, v14
    v_sub_f32 v13, v124, v7
    v_sub_f32 v14, v125, v7
    v_fmac_f32 v5, v13, v13
    v_fmac_f32 v6, v14, v14
    v_sub_f32 v13, v126, v7
    v_sub_f32 v14, v127, v7
    v_fmac_f32 v5, v13, v13
    v_fmac_f32 v6, v14, v14
    v_sub_f32 v13, v128, v7
    v_sub_f32 v14, v129, v7
    v_fmac_f32 v5, v13, v13
    v_fmac_f32 v6, v14, v14
    v_sub_f32 v13, v130, v7
    v_sub_f32 v14, v131, v7
    v_fmac_f32 v5, v13, v13
    v_fmac_f32 v6, v14, v14
    v_sub_f32 v13, v132, v7
    v_sub_f32 v14, v133, v7
    v_fmac_f32 v5, v13, v13
    v_fmac_f32 v6, v14, v14
    v_sub_f32 v13, v134, v7
    v_sub_f32 v14, v135, v7
    v_fmac_f32 v5, v13, v13
    v_fmac_f32 v6, v14, v14
    v_add_f32 v5, v5, v6
    s_nop 1
    v_add_f32_dpp v5, v5, v5 quad_perm:[1,0,3,2] row_mask:0xf bank_mask:0xf
    s_nop 1
    v_add_f32_dpp v5, v5, v5 quad_perm:[2,3,0,1] row_mask:0xf bank_mask:0xf
    s_nop 1
    v_add_f32_dpp v5, v5, v5 row_half_mirror row_mask:0xf bank_mask:0xf
    v_mul_f32 v8, 0x3acccccd, v5
    v_mov_b32 v9, v7
    v_cvt_pk_bf16_f32 v9, v9, v9
    v_and_b32 v9, 0xffff0000, v9
    v_mov_b32 v5, v8
    v_cvt_pk_bf16_f32 v5, v5, v5
    v_and_b32 v5, 0xffff0000, v5
    v_add_f32 v5, 0x3727c5ac, v5
    v_cvt_pk_bf16_f32 v5, v5, v5
    v_and_b32 v5, 0xffff0000, v5
    v_sqrt_f32 v5, v5
    s_nop 0
    v_cvt_pk_bf16_f32 v5, v5, v5
    v_and_b32 v5, 0xffff0000, v5
    v_rcp_f32 v10, v5
    v_sub_f32 v11, v7, v9
    v_mul_f32 v11, v11, v10
    v_cvt_pk_bf16_f32 v11, v11, v11
    v_and_b32 v11, 0xffff0000, v11
    v_mul_f32 v5, v8, v10
    v_mul_f32 v5, v5, v10
    v_cvt_pk_bf16_f32 v5, v5, v5
    v_and_b32 v5, 0xffff0000, v5
    v_add_f32 v5, 0x3727c5ac, v5
    v_cvt_pk_bf16_f32 v5, v5, v5
    v_and_b32 v5, 0xffff0000, v5
    v_sqrt_f32 v5, v5
    s_nop 0
    v_cvt_pk_bf16_f32 v5, v5, v5
    v_and_b32 v5, 0xffff0000, v5
    v_rcp_f32 v12, v5
    v_mov_b32 v16, v10
    v_mul_f32 v17, v9, v10
    v_mul_f32 v20, v10, v12
    v_add_f32 v21, v17, v11
    v_mul_f32 v21, v21, v12
    v_mov_b32 v18, s76
    v_mov_b32 v19, s76
    v_mov_b32 v22, s76
    v_mov_b32 v23, s76
    v_lshlrev_b32 v3, 4, v2
    v_add_u32 v4, 0x8000, v3
    s_mov_b32 exec_lo, 0x01010101
    s_mov_b32 exec_hi, 0x01010101
    buffer_store_dwordx4 v[16:19], v3, s[60:63], 0 offen sc1
    buffer_store_dwordx4 v[20:23], v4, s[60:63], 0 offen sc1
    s_mov_b64 exec, -1
    s_add_u32 s70, s70, 1
    s_cmp_lt_u32 s70, s39
    s_cbranch_scc1 k1_hs1
    s_lshr_b32 s71, s29, 4
    s_lshr_b32 s39, s26, 4
    s_add_u32 s39, s39, s71
k1_hs2:
    s_lshr_b32 s35, s71, 2
    s_cmp_lt_u32 s35, 30
    s_cselect_b32 s12, s6, s48
    s_cselect_b32 s13, s7, s49
    s_cselect_b32 s33, 768, 0
    s_cselect_b32 s34, 0, 30
    s_add_u32 s33, s33, 3072
    s_mul_i32 s14, s33, 640
    s_mov_b32 s15, 0x00020000
    s_cmp_lt_u32 s71, 216
    s_cselect_b32 s14, s14, 0
    s_sub_u32 s34, s35, s34
    s_lshl_b32 s34, s34, 7
    v_lshrrev_b32 v13, 3, v1
    v_mul_lo_u32 v13, v13, s33
    v_and_b32 v14, 7, v1
    v_lshl_add_u32 v13, v14, 4, v13
    v_add_u32 v13, s34, v13
    s_and_b32 s34, s71, 3
    s_mul_i32 s34, s34, 160
    s_mul_i32 s34, s34, s33
    s_lshl_b32 s33, s33, 3
    buffer_load_dwordx4 v[136:139], v13, s[12:15], s34 offen nt
    s_add_u32 s34, s34, s33
    buffer_load_dwordx4 v[140:143], v13, s[12:15], s34 offen nt
    s_add_u32 s34, s34, s33
    buffer_load_dwordx4 v[144:147], v13, s[12:15], s34 offen nt
    s_add_u32 s34, s34, s33
    buffer_load_dwordx4 v[148:151], v13, s[12:15], s34 offen nt
    s_add_u32 s34, s34, s33
    buffer_load_dwordx4 v[152:155], v13, s[12:15], s34 offen nt
    s_add_u32 s34, s34, s33
    buffer_load_dwordx4 v[156:159], v13, s[12:15], s34 offen nt
    s_add_u32 s34, s34, s33
    buffer_load_dwordx4 v[160:163], v13, s[12:15], s34 offen nt
    s_add_u32 s34, s34, s33
    buffer_load_dwordx4 v[164:167], v13, s[12:15], s34 offen nt
    s_add_u32 s34, s34, s33
    buffer_load_dwordx4 v[168:171], v13, s[12:15], s34 offen nt
    s_add_u32 s34, s34, s33
    buffer_load_dwordx4 v[172:175], v13, s[12:15], s34 offen nt
    s_add_u32 s34, s34, s33
    buffer_load_dwordx4 v[176:179], v13, s[12:15], s34 offen nt
    s_add_u32 s34, s34, s33
    buffer_load_dwordx4 v[180:183], v13, s[12:15], s34 offen nt
    s_add_u32 s34, s34, s33
    buffer_load_dwordx4 v[184:187], v13, s[12:15], s34 offen nt
    s_add_u32 s34, s34, s33
    buffer_load_dwordx4 v[188:191], v13, s[12:15], s34 offen nt
    s_add_u32 s34, s34, s33
    buffer_load_dwordx4 v[192:195], v13, s[12:15], s34 offen nt
    s_add_u32 s34, s34, s33
    buffer_load_dwordx4 v[196:199], v13, s[12:15], s34 offen nt
    s_add_u32 s34, s34, s33
    buffer_load_dwordx4 v[200:203], v13, s[12:15], s34 offen nt
    s_add_u32 s34, s34, s33
    buffer_load_dwordx4 v[204:207], v13, s[12:15], s34 offen nt
    s_add_u32 s34, s34, s33
    buffer_load_dwordx4 v[208:211], v13, s[12:15], s34 offen nt
    s_add_u32 s34, s34, s33
    buffer_load_dwordx4 v[212:215], v13, s[12:15], s34 offen nt
    s_waitcnt vmcnt(0)
    v_lshlrev_b32 v216, 16, v136
    v_and_b32 v217, 0xffff0000, v136
    v_lshlrev_b32 v218, 16, v137
    v_and_b32 v219, 0xffff0000, v137
    v_lshlrev_b32 v220, 16, v138
    v_and_b32 v221, 0xffff0000, v138
    v_lshlrev_b32 v222, 16, v139
    v_and_b32 v223, 0xffff0000, v139
    v_lshlrev_b32 v13, 16, v140
    v_and_b32 v14, 0xffff0000, v140
    v_add_f32 v216, v216, v13
    v_add_f32 v217, v217, v14
    v_lshlrev_b32 v13, 16, v141
    v_and_b32 v14, 0xffff0000, v141
    v_add_f32 v218, v218, v13
    v_add_f32 v219, v219, v14
    v_lshlrev_b32 v13, 16, v142
    v_and_b32 v14, 0xffff0000, v142
    v_add_f32 v220, v220, v13
    v_add_f32 v221, v221, v14
    v_lshlrev_b32 v13, 16, v143
    v_and_b32 v14, 0xffff0000, v143
    v_add_f32 v222, v222, v13
    v_add_f32 v223, v223, v14
    v_lshlrev_b32 v13, 16, v144
    v_and_b32 v14, 0xffff0000, v144
    v_add_f32 v216, v216, v13
    v_add_f32 v217, v217, v14
    v_lshlrev_b32 v13, 16, v145
    v_and_b32 v14, 0xffff0000, v145
    v_add_f32 v218, v218, v13
    v_add_f32 v219, v219, v14
    v_lshlrev_b32 v13, 16, v146
    v_and_b32 v14, 0xffff0000, v146
    v_add_f32 v220, v220, v13
    v_add_f32 v221, v221, v14
    v_lshlrev_b32 v13, 16, v147
    v_and_b32 v14, 0xffff0000, v147
    v_add_f32 v222, v222, v13
    v_add_f32 v223, v223, v14
    v_lshlrev_b32 v13, 16, v148
    v_and_b32 v14, 0xffff0000, v148
    v_add_f32 v216, v216, v13
    v_add_f32 v217, v217, v14
    v_lshlrev_b32 v13, 16, v149
    v_and_b32 v14, 0xffff0000, v149
    v_add_f32 v218, v218, v13
    v_add_f32 v219, v219, v14
    v_lshlrev_b32 v13, 16, v150
    v_and_b32 v14, 0xffff0000, v150
    v_add_f32 v220, v220, v13
    v_add_f32 v221, v221, v14
    v_lshlrev_b32 v13, 16, v151
    v_and_b32 v14, 0xffff0000, v151
    v_add_f32 v222, v222, v13
    v_add_f32 v223, v223, v14
    v_lshlrev_b32 v13, 16, v152
    v_and_b32 v14, 0xffff0000, v152
    v_add_f32 v216, v216, v13
    v_add_f32 v217, v217, v14
    v_lshlrev_b32 v13, 16, v153
    v_and_b32 v14, 0xffff0000, v153
    v_add_f32 v218, v218, v13
    v_add_f32 v219, v219, v14
    v_lshlrev_b32 v13, 16, v154
    v_and_b32 v14, 0xffff0000, v154
    v_add_f32 v220, v220, v13
    v_add_f32 v221, v221, v14
    v_lshlrev_b32 v13, 16, v155
    v_and_b32 v14, 0xffff0000, v155
    v_add_f32 v222, v222, v13
    v_add_f32 v223, v223, v14
    v_lshlrev_b32 v13, 16, v156
    v_and_b32 v14, 0xffff0000, v156
    v_add_f32 v216, v216, v13
    v_add_f32 v217, v217, v14
    v_lshlrev_b32 v13, 16, v157
    v_and_b32 v14, 0xffff0000, v157
    v_add_f32 v218, v218, v13
    v_add_f32 v219, v219, v14
    v_lshlrev_b32 v13, 16, v158
    v_and_b32 v14, 0xffff0000, v158
    v_add_f32 v220, v220, v13
    v_add_f32 v221, v221, v14
    v_lshlrev_b32 v13, 16, v159
    v_and_b32 v14, 0xffff0000, v159
    v_add_f32 v222, v222, v13
    v_add_f32 v223, v223, v14
    v_lshlrev_b32 v13, 16, v160
    v_and_b32 v14, 0xffff0000, v160
    v_add_f32 v216, v216, v13
    v_add_f32 v217, v217, v14
    v_lshlrev_b32 v13, 16, v161
    v_and_b32 v14, 0xffff0000, v161
    v_add_f32 v218, v218, v13
    v_add_f32 v219, v219, v14
    v_lshlrev_b32 v13, 16, v162
    v_and_b32 v14, 0xffff0000, v162
    v_add_f32 v220, v220, v13
    v_add_f32 v221, v221, v14
    v_lshlrev_b32 v13, 16, v163
    v_and_b32 v14, 0xffff0000, v163
    v_add_f32 v222, v222, v13
    v_add_f32 v223, v223, v14
    v_lshlrev_b32 v13, 16, v164
    v_and_b32 v14, 0xffff0000, v164
    v_add_f32 v216, v216, v13
    v_add_f32 v217, v217, v14
    v_lshlrev_b32 v13, 16, v165
    v_and_b32 v14, 0xffff0000, v165
    v_add_f32 v218, v218, v13
    v_add_f32 v219, v219, v14
    v_lshlrev_b32 v13, 16, v166
    v_and_b32 v14, 0xffff0000, v166
    v_add_f32 v220, v220, v13
    v_add_f32 v221, v221, v14
    v_lshlrev_b32 v13, 16, v167
    v_and_b32 v14, 0xffff0000, v167
    v_add_f32 v222, v222, v13
    v_add_f32 v223, v223, v14
    v_lshlrev_b32 v13, 16, v168
    v_and_b32 v14, 0xffff0000, v168
    v_add_f32 v216, v216, v13
    v_add_f32 v217, v217, v14
    v_lshlrev_b32 v13, 16, v169
    v_and_b32 v14, 0xffff0000, v169
    v_add_f32 v218, v218, v13
    v_add_f32 v219, v219, v14
    v_lshlrev_b32 v13, 16, v170
    v_and_b32 v14, 0xffff0000, v170
    v_add_f32 v220, v220, v13
    v_add_f32 v221, v221, v14
    v_lshlrev_b32 v13, 16, v171
    v_and_b32 v14, 0xffff0000, v171
    v_add_f32 v222, v222, v13
    v_add_f32 v223, v223, v14
    v_lshlrev_b32 v13, 16, v172
    v_and_b32 v14, 0xffff0000, v172
    v_add_f32 v216, v216, v13
    v_add_f32 v217, v217, v14
    v_lshlrev_b32 v13, 16, v173
    v_and_b32 v14, 0xffff0000, v173
    v_add_f32 v218, v218, v13
    v_add_f32 v219, v219, v14
    v_lshlrev_b32 v13, 16, v174
    v_and_b32 v14, 0xffff0000, v174
    v_add_f32 v220, v220, v13
    v_add_f32 v221, v221, v14
    v_lshlrev_b32 v13, 16, v175
    v_and_b32 v14, 0xffff0000, v175
    v_add_f32 v222, v222, v13
    v_add_f32 v223, v223, v14
    v_lshlrev_b32 v13, 16, v176
    v_and_b32 v14, 0xffff0000, v176
    v_add_f32 v216, v216, v13
    v_add_f32 v217, v217, v14
    v_lshlrev_b32 v13, 16, v177
    v_and_b32 v14, 0xffff0000, v177
    v_add_f32 v218, v218, v13
    v_add_f32 v219, v219, v14
    v_lshlrev_b32 v13, 16, v178
    v_and_b32 v14, 0xffff0000, v178
    v_add_f32 v220, v220, v13
    v_add_f32 v221, v221, v14
    v_lshlrev_b32 v13, 16, v179
    v_and_b32 v14, 0xffff0000, v179
    v_add_f32 v222, v222, v13
    v_add_f32 v223, v223, v14
    v_lshlrev_b32 v13, 16, v180
    v_and_b32 v14, 0xffff0000, v180
    v_add_f32 v216, v216, v13
    v_add_f32 v217, v217, v14
    v_lshlrev_b32 v13, 16, v181
    v_and_b32 v14, 0xffff0000, v181
    v_add_f32 v218, v218, v13
    v_add_f32 v219, v219, v14
    v_lshlrev_b32 v13, 16, v182
    v_and_b32 v14, 0xffff0000, v182
    v_add_f32 v220, v220, v13
    v_add_f32 v221, v221, v14
    v_lshlrev_b32 v13, 16, v183
    v_and_b32 v14, 0xffff0000, v183
    v_add_f32 v222, v222, v13
    v_add_f32 v223, v223, v14
    v_lshlrev_b32 v13, 16, v184
    v_and_b32 v14, 0xffff0000, v184
    v_add_f32 v216, v216, v13
    v_add_f32 v217, v217, v14
    v_lshlrev_b32 v13, 16, v185
    v_and_b32 v14, 0xffff0000, v185
    v_add_f32 v218, v218, v13
    v_add_f32 v219, v219, v14
    v_lshlrev_b32 v13, 16, v186
    v_and_b32 v14, 0xffff0000, v186
    v_add_f32 v220, v220, v13
    v_add_f32 v221, v221, v14
    v_lshlrev_b32 v13, 16, v187
    v_and_b32 v14, 0xffff0000, v187
    v_add_f32 v222, v222, v13
    v_add_f32 v223, v223, v14
    v_lshlrev_b32 v13, 16, v188
    v_and_b32 v14, 0xffff0000, v188
    v_add_f32 v216, v216, v13
    v_add_f32 v217, v217, v14
    v_lshlrev_b32 v13, 16, v189
    v_and_b32 v14, 0xffff0000, v189
    v_add_f32 v218, v218, v13
    v_add_f32 v219, v219, v14
    v_lshlrev_b32 v13, 16, v190
    v_and_b32 v14, 0xffff0000, v190
    v_add_f32 v220, v220, v13
    v_add_f32 v221, v221, v14
    v_lshlrev_b32 v13, 16, v191
    v_and_b32 v14, 0xffff0000, v191
    v_add_f32 v222, v222, v13
    v_add_f32 v223, v223, v14
    v_lshlrev_b32 v13, 16, v192
    v_and_b32 v14, 0xffff0000, v192
    v_add_f32 v216, v216, v13
    v_add_f32 v217, v217, v14
    v_lshlrev_b32 v13, 16, v193
    v_and_b32 v14, 0xffff0000, v193
    v_add_f32 v218, v218, v13
    v_add_f32 v219, v219, v14
    v_lshlrev_b32 v13, 16, v194
    v_and_b32 v14, 0xffff0000, v194
    v_add_f32 v220, v220, v13
    v_add_f32 v221, v221, v14
    v_lshlrev_b32 v13, 16, v195
    v_and_b32 v14, 0xffff0000, v195
    v_add_f32 v222, v222, v13
    v_add_f32 v223, v223, v14
    v_lshlrev_b32 v13, 16, v196
    v_and_b32 v14, 0xffff0000, v196
    v_add_f32 v216, v216, v13
    v_add_f32 v217, v217, v14
    v_lshlrev_b32 v13, 16, v197
    v_and_b32 v14, 0xffff0000, v197
    v_add_f32 v218, v218, v13
    v_add_f32 v219, v219, v14
    v_lshlrev_b32 v13, 16, v198
    v_and_b32 v14, 0xffff0000, v198
    v_add_f32 v220, v220, v13
    v_add_f32 v221, v221, v14
    v_lshlrev_b32 v13, 16, v199
    v_and_b32 v14, 0xffff0000, v199
    v_add_f32 v222, v222, v13
    v_add_f32 v223, v223, v14
    v_lshlrev_b32 v13, 16, v200
    v_and_b32 v14, 0xffff0000, v200
    v_add_f32 v216, v216, v13
    v_add_f32 v217, v217, v14
    v_lshlrev_b32 v13, 16, v201
    v_and_b32 v14, 0xffff0000, v201
    v_add_f32 v218, v218, v13
    v_add_f32 v219, v219, v14
    v_lshlrev_b32 v13, 16, v202
    v_and_b32 v14, 0xffff0000, v202
    v_add_f32 v220, v220, v13
    v_add_f32 v221, v221, v14
    v_lshlrev_b32 v13, 16, v203
    v_and_b32 v14, 0xffff0000, v203
    v_add_f32 v222, v222, v13
    v_add_f32 v223, v223, v14
    v_lshlrev_b32 v13, 16, v204
    v_and_b32 v14, 0xffff0000, v204
    v_add_f32 v216, v216, v13
    v_add_f32 v217, v217, v14
    v_lshlrev_b32 v13, 16, v205
    v_and_b32 v14, 0xffff0000, v205
    v_add_f32 v218, v218, v13
    v_add_f32 v219, v219, v14
    v_lshlrev_b32 v13, 16, v206
    v_and_b32 v14, 0xffff0000, v206
    v_add_f32 v220, v220, v13
    v_add_f32 v221, v221, v14
    v_lshlrev_b32 v13, 16, v207
    v_and_b32 v14, 0xffff0000, v207
    v_add_f32 v222, v222, v13
    v_add_f32 v223, v223, v14
    v_lshlrev_b32 v13, 16, v208
    v_and_b32 v14, 0xffff0000, v208
    v_add_f32 v216, v216, v13
    v_add_f32 v217, v217, v14
    v_lshlrev_b32 v13, 16, v209
    v_and_b32 v14, 0xffff0000, v209
    v_add_f32 v218, v218, v13
    v_add_f32 v219, v219, v14
    v_lshlrev_b32 v13, 16, v210
    v_and_b32 v14, 0xffff0000, v210
    v_add_f32 v220, v220, v13
    v_add_f32 v221, v221, v14
    v_lshlrev_b32 v13, 16, v211
    v_and_b32 v14, 0xffff0000, v211
    v_add_f32 v222, v222, v13
    v_add_f32 v223, v223, v14
    v_lshlrev_b32 v13, 16, v212
    v_and_b32 v14, 0xffff0000, v212
    v_add_f32 v216, v216, v13
    v_add_f32 v217, v217, v14
    v_lshlrev_b32 v13, 16, v213
    v_and_b32 v14, 0xffff0000, v213
    v_add_f32 v218, v218, v13
    v_add_f32 v219, v219, v14
    v_lshlrev_b32 v13, 16, v214
    v_and_b32 v14, 0xffff0000, v214
    v_add_f32 v220, v220, v13
    v_add_f32 v221, v221, v14
    v_lshlrev_b32 v13, 16, v215
    v_and_b32 v14, 0xffff0000, v215
    v_add_f32 v222, v222, v13
    v_add_f32 v223, v223, v14
    s_nop 1
    v_add_f32_dpp v216, v216, v216 row_ror:8 row_mask:0xf bank_mask:0xf
    v_add_f32_dpp v217, v217, v217 row_ror:8 row_mask:0xf bank_mask:0xf
    v_add_f32_dpp v218, v218, v218 row_ror:8 row_mask:0xf bank_mask:0xf
    v_add_f32_dpp v219, v219, v219 row_ror:8 row_mask:0xf bank_mask:0xf
    v_add_f32_dpp v220, v220, v220 row_ror:8 row_mask:0xf bank_mask:0xf
    v_add_f32_dpp v221, v221, v221 row_ror:8 row_mask:0xf bank_mask:0xf
    v_add_f32_dpp v222, v222, v222 row_ror:8 row_mask:0xf bank_mask:0xf
    v_add_f32_dpp v223, v223, v223 row_ror:8 row_mask:0xf bank_mask:0xf
    v_mov_b32 v224, v216
    v_mov_b32 v225, v217
    v_mov_b32 v226, v218
    v_mov_b32 v227, v219
    v_mov_b32 v228, v220
    v_mov_b32 v229, v221
    v_mov_b32 v230, v222
    v_mov_b32 v231, v223
    s_nop 1
    v_permlane16_swap_b32 v216, v224
    v_permlane16_swap_b32 v217, v225
    v_permlane16_swap_b32 v218, v226
    v_permlane16_swap_b32 v219, v227
    v_permlane16_swap_b32 v220, v228
    v_permlane16_swap_b32 v221, v229
    v_permlane16_swap_b32 v222, v230
    v_permlane16_swap_b32 v223, v231
    s_nop 1
    v_add_f32 v216, v216, v224
    v_add_f32 v217, v217, v225
    v_add_f32 v218, v218, v226
    v_add_f32 v219, v219, v227
    v_add_f32 v220, v220, v228
    v_add_f32 v221, v221, v229
    v_add_f32 v222, v222, v230
    v_add_f32 v223, v223, v231
    v_mov_b32 v224, v216
    v_mov_b32 v225, v217
    v_mov_b32 v226, v218
    v_mov_b32 v227, v219
    v_mov_b32 v228, v220
    v_mov_b32 v229, v221
    v_mov_b32 v230, v222
    v_mov_b32 v231, v223
    s_nop 1
    v_permlane32_swap_b32 v216, v224
    v_permlane32_swap_b32 v217, v225
    v_permlane32_swap_b32 v218, v226
    v_permlane32_swap_b32 v219, v227
    v_permlane32_swap_b32 v220, v228
    v_permlane32_swap_b32 v221, v229
    v_permlane32_swap_b32 v222, v230
    v_permlane32_swap_b32 v223, v231
    s_nop 1
    v_add_f32 v216, v216, v224
    v_add_f32 v217, v217, v225
    v_add_f32 v218, v218, v226
    v_add_f32 v219, v219, v227
    v_add_f32 v220, v220, v228
    v_add_f32 v221, v221, v229
    v_add_f32 v222, v222, v230
    v_add_f32 v223, v223, v231
    v_lshrrev_b32 v13, 3, v1
    v_mov_b32 v224, v216
    v_cmp_eq_u32 vcc, 1, v13
    s_nop 1
    v_cndmask_b32 v224, v224, v217, vcc
    v_cmp_eq_u32 vcc, 2, v13
    s_nop 1
    v_cndmask_b32 v224, v224, v218, vcc
    v_cmp_eq_u32 vcc, 3, v13
    s_nop 1
    v_cndmask_b32 v224, v224, v219, vcc
    v_cmp_eq_u32 vcc, 4, v13
    s_nop 1
    v_cndmask_b32 v224, v224, v220, vcc
    v_cmp_eq_u32 vcc, 5, v13
    s_nop 1
    v_cndmask_b32 v224, v224, v221, vcc
    v_cmp_eq_u32 vcc, 6, v13
    s_nop 1
    v_cndmask_b32 v224, v224, v222, vcc
    v_cmp_eq_u32 vcc, 7, v13
    s_nop 1
    v_cndmask_b32 v224, v224, v223, vcc
    v_mov_b32 v225, s76
    v_and_b32 v14, 7, v1
    v_lshl_add_u32 v13, v14, 3, v13
    s_lshr_b32 s33, s71, 2
    s_lshl_b32 s33, s33, 9
    s_and_b32 s34, s71, 3
    s_lshl_b32 s34, s34, 15
    s_add_u32 s33, s33, s34
    s_add_u32 s33, s33, 65536
    v_lshl_add_u32 v13, v13, 3, s33
    s_cmp_lt_u32 s71, 216
    s_cselect_b32 s33, 0, 0x40000000
    buffer_store_dwordx2 v[224:225], v13, s[60:63], s33 offen sc1
    s_add_u32 s71, s71, 1
    s_cmp_lt_u32 s71, s39
    s_cbranch_scc1 k1_hs2
    s_waitcnt vmcnt(0)
    buffer_load_dwordx4 v[16:19], v243, s[60:63], 0 offen offset:0 sc1
    buffer_load_dwordx4 v[20:23], v243, s[60:63], 0 offen offset:1024 sc1
    buffer_load_dwordx4 v[24:27], v243, s[60:63], 0 offen offset:2048 sc1
    buffer_load_dwordx4 v[28:31], v243, s[60:63], 0 offen offset:3072 sc1
    buffer_load_dwordx2 v[32:33], v244, s[60:63], s68 offen offset:0 sc1
    buffer_load_dwordx2 v[34:35], v244, s[60:63], s68 offen offset:512 sc1
    buffer_load_dwordx2 v[36:37], v244, s[60:63], s68 offen offset:1024 sc1
    buffer_load_dwordx2 v[38:39], v244, s[60:63], s69 offen offset:0 sc1
    buffer_load_dwordx2 v[40:41], v244, s[60:63], s69 offen offset:512 sc1
    buffer_load_dwordx2 v[42:43], v244, s[60:63], s69 offen offset:1024 sc1
    buffer_load_dwordx2 v[44:45], v244, s[60:63], s74 offen offset:0 sc1
    buffer_load_dwordx2 v[46:47], v244, s[60:63], s74 offen offset:512 sc1
    buffer_load_dwordx2 v[48:49], v244, s[60:63], s74 offen offset:1024 sc1
    buffer_load_dwordx2 v[50:51], v244, s[60:63], s75 offen offset:0 sc1
    buffer_load_dwordx2 v[52:53], v244, s[60:63], s75 offen offset:512 sc1
    buffer_load_dwordx2 v[54:55], v244, s[60:63], s75 offen offset:1024 sc1
    s_waitcnt vmcnt(0)
k1_hok:
    v_lshlrev_b32 v12, 3, v1
    v_add_u32 v12, 147456, v12
    v_lshlrev_b32 v13, 2, v1
    v_add_u32 v13, 147456, v13
    v_mul_f32 v16, s45, v16
    v_mul_f32 v17, s45, v17
    ds_write_b64 v12, v[16:17] offset:0
    ds_write_b32 v13, v16 offset:2048
    ds_write_b32 v13, v17 offset:3072
    v_mul_f32 v20, s45, v20
    v_mul_f32 v21, s45, v21
    ds_write_b64 v12, v[20:21] offset:512
    ds_write_b32 v13, v20 offset:2304
    ds_write_b32 v13, v21 offset:3328
    v_mul_f32 v24, s45, v24
    v_mul_f32 v25, s45, v25
    ds_write_b64 v12, v[24:25] offset:1024
    ds_write_b32 v13, v24 offset:2560
    ds_write_b32 v13, v25 offset:3584
    v_mul_f32 v28, s45, v28
    v_mul_f32 v29, s45, v29
    ds_write_b64 v12, v[28:29] offset:1536
    ds_write_b32 v13, v28 offset:2816
    ds_write_b32 v13, v29 offset:3840
    v_lshlrev_b32 v232, 16, v232
    v_add_f32 v32, v32, v38
    v_add_f32 v32, v32, v44
    v_add_f32 v32, v32, v50
    ds_write_b32 v13, v32 offset:4096
    ds_write_b32 v13, v232 offset:4864
    v_lshlrev_b32 v233, 16, v233
    v_add_f32 v34, v34, v40
    v_add_f32 v34, v34, v46
    v_add_f32 v34, v34, v52
    ds_write_b32 v13, v34 offset:4352
    ds_write_b32 v13, v233 offset:5120
    v_lshlrev_b32 v234, 16, v234
    v_add_f32 v36, v36, v42
    v_add_f32 v36, v36, v48
    v_add_f32 v36, v36, v54
    ds_write_b32 v13, v36 offset:4608
    ds_write_b32 v13, v234 offset:5376
    s_waitcnt lgkmcnt(0)
    s_cmp_eq_u32 s38, 0
    s_cbranch_scc0 k1_hw
    s_barrier
k1_hw:
    s_barrier
    s_endpgm
k1_hB:
    s_lshr_b32 s35, s71, 2
    s_cmp_lt_u32 s35, 30
    s_cselect_b32 s12, s6, s48
    s_cselect_b32 s13, s7, s49
    s_cselect_b32 s33, 768, 0
    s_cselect_b32 s34, 0, 30
    s_add_u32 s33, s33, 3072
    s_mul_i32 s14, s33, 640
    s_mov_b32 s15, 0x00020000
    s_cmp_lt_u32 s71, 216
    s_cselect_b32 s14, s14, 0
    s_sub_u32 s34, s35, s34
    s_lshl_b32 s34, s34, 7
    v_lshrrev_b32 v13, 3, v1
    v_mul_lo_u32 v13, v13, s33
    v_and_b32 v14, 7, v1
    v_lshl_add_u32 v13, v14, 4, v13
    v_add_u32 v13, s34, v13
    s_and_b32 s34, s71, 3
    s_mul_i32 s34, s34, 160
    s_mul_i32 s34, s34, s33
    s_lshl_b32 s33, s33, 3
    buffer_load_dwordx4 v[136:139], v13, s[12:15], s34 offen nt
    s_add_u32 s34, s34, s33
    buffer_load_dwordx4 v[140:143], v13, s[12:15], s34 offen nt
    s_add_u32 s34, s34, s33
    buffer_load_dwordx4 v[144:147], v13, s[12:15], s34 offen nt
    s_add_u32 s34, s34, s33
    buffer_load_dwordx4 v[148:151], v13, s[12:15], s34 offen nt
    s_add_u32 s34, s34, s33
    buffer_load_dwordx4 v[152:155], v13, s[12:15], s34 offen nt
    s_add_u32 s34, s34, s33
    buffer_load_dwordx4 v[156:159], v13, s[12:15], s34 offen nt
    s_add_u32 s34, s34, s33
    buffer_load_dwordx4 v[160:163], v13, s[12:15], s34 offen nt
    s_add_u32 s34, s34, s33
    buffer_load_dwordx4 v[164:167], v13, s[12:15], s34 offen nt
    s_add_u32 s34, s34, s33
    buffer_load_dwordx4 v[168:171], v13, s[12:15], s34 offen nt
    s_add_u32 s34, s34, s33
    buffer_load_dwordx4 v[172:175], v13, s[12:15], s34 offen nt
    s_add_u32 s34, s34, s33
    buffer_load_dwordx4 v[176:179], v13, s[12:15], s34 offen nt
    s_add_u32 s34, s34, s33
    buffer_load_dwordx4 v[180:183], v13, s[12:15], s34 offen nt
    s_add_u32 s34, s34, s33
    buffer_load_dwordx4 v[184:187], v13, s[12:15], s34 offen nt
    s_add_u32 s34, s34, s33
    buffer_load_dwordx4 v[188:191], v13, s[12:15], s34 offen nt
    s_add_u32 s34, s34, s33
    buffer_load_dwordx4 v[192:195], v13, s[12:15], s34 offen nt
    s_add_u32 s34, s34, s33
    buffer_load_dwordx4 v[196:199], v13, s[12:15], s34 offen nt
    s_add_u32 s34, s34, s33
    buffer_load_dwordx4 v[200:203], v13, s[12:15], s34 offen nt
    s_add_u32 s34, s34, s33
    buffer_load_dwordx4 v[204:207], v13, s[12:15], s34 offen nt
    s_add_u32 s34, s34, s33
    buffer_load_dwordx4 v[208:211], v13, s[12:15], s34 offen nt
    s_add_u32 s34, s34, s33
    buffer_load_dwordx4 v[212:215], v13, s[12:15], s34 offen nt
    s_barrier
    s_waitcnt vmcnt(15)
    v_lshlrev_b32 v216, 16, v136
    v_and_b32 v217, 0xffff0000, v136
    v_lshlrev_b32 v218, 16, v137
    v_and_b32 v219, 0xffff0000, v137
    v_lshlrev_b32 v220, 16, v138
    v_and_b32 v221, 0xffff0000, v138
    v_lshlrev_b32 v222, 16, v139
    v_and_b32 v223, 0xffff0000, v139
    v_lshlrev_b32 v13, 16, v140
    v_and_b32 v14, 0xffff0000, v140
    v_add_f32 v216, v216, v13
    v_add_f32 v217, v217, v14
    v_lshlrev_b32 v13, 16, v141
    v_and_b32 v14, 0xffff0000, v141
    v_add_f32 v218, v218, v13
    v_add_f32 v219, v219, v14
    v_lshlrev_b32 v13, 16, v142
    v_and_b32 v14, 0xffff0000, v142
    v_add_f32 v220, v220, v13
    v_add_f32 v221, v221, v14
    v_lshlrev_b32 v13, 16, v143
    v_and_b32 v14, 0xffff0000, v143
    v_add_f32 v222, v222, v13
    v_add_f32 v223, v223, v14
    v_lshlrev_b32 v13, 16, v144
    v_and_b32 v14, 0xffff0000, v144
    v_add_f32 v216, v216, v13
    v_add_f32 v217, v217, v14
    v_lshlrev_b32 v13, 16, v145
    v_and_b32 v14, 0xffff0000, v145
    v_add_f32 v218, v218, v13
    v_add_f32 v219, v219, v14
    v_lshlrev_b32 v13, 16, v146
    v_and_b32 v14, 0xffff0000, v146
    v_add_f32 v220, v220, v13
    v_add_f32 v221, v221, v14
    v_lshlrev_b32 v13, 16, v147
    v_and_b32 v14, 0xffff0000, v147
    v_add_f32 v222, v222, v13
    v_add_f32 v223, v223, v14
    v_lshlrev_b32 v13, 16, v148
    v_and_b32 v14, 0xffff0000, v148
    v_add_f32 v216, v216, v13
    v_add_f32 v217, v217, v14
    v_lshlrev_b32 v13, 16, v149
    v_and_b32 v14, 0xffff0000, v149
    v_add_f32 v218, v218, v13
    v_add_f32 v219, v219, v14
    v_lshlrev_b32 v13, 16, v150
    v_and_b32 v14, 0xffff0000, v150
    v_add_f32 v220, v220, v13
    v_add_f32 v221, v221, v14
    v_lshlrev_b32 v13, 16, v151
    v_and_b32 v14, 0xffff0000, v151
    v_add_f32 v222, v222, v13
    v_add_f32 v223, v223, v14
    v_lshlrev_b32 v13, 16, v152
    v_and_b32 v14, 0xffff0000, v152
    v_add_f32 v216, v216, v13
    v_add_f32 v217, v217, v14
    v_lshlrev_b32 v13, 16, v153
    v_and_b32 v14, 0xffff0000, v153
    v_add_f32 v218, v218, v13
    v_add_f32 v219, v219, v14
    v_lshlrev_b32 v13, 16, v154
    v_and_b32 v14, 0xffff0000, v154
    v_add_f32 v220, v220, v13
    v_add_f32 v221, v221, v14
    v_lshlrev_b32 v13, 16, v155
    v_and_b32 v14, 0xffff0000, v155
    v_add_f32 v222, v222, v13
    v_add_f32 v223, v223, v14
    s_barrier
    s_waitcnt vmcnt(10)
    v_lshlrev_b32 v13, 16, v156
    v_and_b32 v14, 0xffff0000, v156
    v_add_f32 v216, v216, v13
    v_add_f32 v217, v217, v14
    v_lshlrev_b32 v13, 16, v157
    v_and_b32 v14, 0xffff0000, v157
    v_add_f32 v218, v218, v13
    v_add_f32 v219, v219, v14
    v_lshlrev_b32 v13, 16, v158
    v_and_b32 v14, 0xffff0000, v158
    v_add_f32 v220, v220, v13
    v_add_f32 v221, v221, v14
    v_lshlrev_b32 v13, 16, v159
    v_and_b32 v14, 0xffff0000, v159
    v_add_f32 v222, v222, v13
    v_add_f32 v223, v223, v14
    v_lshlrev_b32 v13, 16, v160
    v_and_b32 v14, 0xffff0000, v160
    v_add_f32 v216, v216, v13
    v_add_f32 v217, v217, v14
    v_lshlrev_b32 v13, 16, v161
    v_and_b32 v14, 0xffff0000, v161
    v_add_f32 v218, v218, v13
    v_add_f32 v219, v219, v14
    v_lshlrev_b32 v13, 16, v162
    v_and_b32 v14, 0xffff0000, v162
    v_add_f32 v220, v220, v13
    v_add_f32 v221, v221, v14
    v_lshlrev_b32 v13, 16, v163
    v_and_b32 v14, 0xffff0000, v163
    v_add_f32 v222, v222, v13
    v_add_f32 v223, v223, v14
    v_lshlrev_b32 v13, 16, v164
    v_and_b32 v14, 0xffff0000, v164
    v_add_f32 v216, v216, v13
    v_add_f32 v217, v217, v14
    v_lshlrev_b32 v13, 16, v165
    v_and_b32 v14, 0xffff0000, v165
    v_add_f32 v218, v218, v13
    v_add_f32 v219, v219, v14
    v_lshlrev_b32 v13, 16, v166
    v_and_b32 v14, 0xffff0000, v166
    v_add_f32 v220, v220, v13
    v_add_f32 v221, v221, v14
    v_lshlrev_b32 v13, 16, v167
    v_and_b32 v14, 0xffff0000, v167
    v_add_f32 v222, v222, v13
    v_add_f32 v223, v223, v14
    v_lshlrev_b32 v13, 16, v168
    v_and_b32 v14, 0xffff0000, v168
    v_add_f32 v216, v216, v13
    v_add_f32 v217, v217, v14
    v_lshlrev_b32 v13, 16, v169
    v_and_b32 v14, 0xffff0000, v169
    v_add_f32 v218, v218, v13
    v_add_f32 v219, v219, v14
    v_lshlrev_b32 v13, 16, v170
    v_and_b32 v14, 0xffff0000, v170
    v_add_f32 v220, v220, v13
    v_add_f32 v221, v221, v14
    v_lshlrev_b32 v13, 16, v171
    v_and_b32 v14, 0xffff0000, v171
    v_add_f32 v222, v222, v13
    v_add_f32 v223, v223, v14
    v_lshlrev_b32 v13, 16, v172
    v_and_b32 v14, 0xffff0000, v172
    v_add_f32 v216, v216, v13
    v_add_f32 v217, v217, v14
    v_lshlrev_b32 v13, 16, v173
    v_and_b32 v14, 0xffff0000, v173
    v_add_f32 v218, v218, v13
    v_add_f32 v219, v219, v14
    v_lshlrev_b32 v13, 16, v174
    v_and_b32 v14, 0xffff0000, v174
    v_add_f32 v220, v220, v13
    v_add_f32 v221, v221, v14
    v_lshlrev_b32 v13, 16, v175
    v_and_b32 v14, 0xffff0000, v175
    v_add_f32 v222, v222, v13
    v_add_f32 v223, v223, v14
    s_barrier
    s_waitcnt vmcnt(0)
    v_lshlrev_b32 v13, 16, v176
    v_and_b32 v14, 0xffff0000, v176
    v_add_f32 v216, v216, v13
    v_add_f32 v217, v217, v14
    v_lshlrev_b32 v13, 16, v177
    v_and_b32 v14, 0xffff0000, v177
    v_add_f32 v218, v218, v13
    v_add_f32 v219, v219, v14
    v_lshlrev_b32 v13, 16, v178
    v_and_b32 v14, 0xffff0000, v178
    v_add_f32 v220, v220, v13
    v_add_f32 v221, v221, v14
    v_lshlrev_b32 v13, 16, v179
    v_and_b32 v14, 0xffff0000, v179
    v_add_f32 v222, v222, v13
    v_add_f32 v223, v223, v14
    v_lshlrev_b32 v13, 16, v180
    v_and_b32 v14, 0xffff0000, v180
    v_add_f32 v216, v216, v13
    v_add_f32 v217, v217, v14
    v_lshlrev_b32 v13, 16, v181
    v_and_b32 v14, 0xffff0000, v181
    v_add_f32 v218, v218, v13
    v_add_f32 v219, v219, v14
    v_lshlrev_b32 v13, 16, v182
    v_and_b32 v14, 0xffff0000, v182
    v_add_f32 v220, v220, v13
    v_add_f32 v221, v221, v14
    v_lshlrev_b32 v13, 16, v183
    v_and_b32 v14, 0xffff0000, v183
    v_add_f32 v222, v222, v13
    v_add_f32 v223, v223, v14
    v_lshlrev_b32 v13, 16, v184
    v_and_b32 v14, 0xffff0000, v184
    v_add_f32 v216, v216, v13
    v_add_f32 v217, v217, v14
    v_lshlrev_b32 v13, 16, v185
    v_and_b32 v14, 0xffff0000, v185
    v_add_f32 v218, v218, v13
    v_add_f32 v219, v219, v14
    v_lshlrev_b32 v13, 16, v186
    v_and_b32 v14, 0xffff0000, v186
    v_add_f32 v220, v220, v13
    v_add_f32 v221, v221, v14
    v_lshlrev_b32 v13, 16, v187
    v_and_b32 v14, 0xffff0000, v187
    v_add_f32 v222, v222, v13
    v_add_f32 v223, v223, v14
    v_lshlrev_b32 v13, 16, v188
    v_and_b32 v14, 0xffff0000, v188
    v_add_f32 v216, v216, v13
    v_add_f32 v217, v217, v14
    v_lshlrev_b32 v13, 16, v189
    v_and_b32 v14, 0xffff0000, v189
    v_add_f32 v218, v218, v13
    v_add_f32 v219, v219, v14
    v_lshlrev_b32 v13, 16, v190
    v_and_b32 v14, 0xffff0000, v190
    v_add_f32 v220, v220, v13
    v_add_f32 v221, v221, v14
    v_lshlrev_b32 v13, 16, v191
    v_and_b32 v14, 0xffff0000, v191
    v_add_f32 v222, v222, v13
    v_add_f32 v223, v223, v14
    v_lshlrev_b32 v13, 16, v192
    v_and_b32 v14, 0xffff0000, v192
    v_add_f32 v216, v216, v13
    v_add_f32 v217, v217, v14
    v_lshlrev_b32 v13, 16, v193
    v_and_b32 v14, 0xffff0000, v193
    v_add_f32 v218, v218, v13
    v_add_f32 v219, v219, v14
    v_lshlrev_b32 v13, 16, v194
    v_and_b32 v14, 0xffff0000, v194
    v_add_f32 v220, v220, v13
    v_add_f32 v221, v221, v14
    v_lshlrev_b32 v13, 16, v195
    v_and_b32 v14, 0xffff0000, v195
    v_add_f32 v222, v222, v13
    v_add_f32 v223, v223, v14
    s_barrier
    v_lshlrev_b32 v13, 16, v196
    v_and_b32 v14, 0xffff0000, v196
    v_add_f32 v216, v216, v13
    v_add_f32 v217, v217, v14
    v_lshlrev_b32 v13, 16, v197
    v_and_b32 v14, 0xffff0000, v197
    v_add_f32 v218, v218, v13
    v_add_f32 v219, v219, v14
    v_lshlrev_b32 v13, 16, v198
    v_and_b32 v14, 0xffff0000, v198
    v_add_f32 v220, v220, v13
    v_add_f32 v221, v221, v14
    v_lshlrev_b32 v13, 16, v199
    v_and_b32 v14, 0xffff0000, v199
    v_add_f32 v222, v222, v13
    v_add_f32 v223, v223, v14
    v_lshlrev_b32 v13, 16, v200
    v_and_b32 v14, 0xffff0000, v200
    v_add_f32 v216, v216, v13
    v_add_f32 v217, v217, v14
    v_lshlrev_b32 v13, 16, v201
    v_and_b32 v14, 0xffff0000, v201
    v_add_f32 v218, v218, v13
    v_add_f32 v219, v219, v14
    v_lshlrev_b32 v13, 16, v202
    v_and_b32 v14, 0xffff0000, v202
    v_add_f32 v220, v220, v13
    v_add_f32 v221, v221, v14
    v_lshlrev_b32 v13, 16, v203
    v_and_b32 v14, 0xffff0000, v203
    v_add_f32 v222, v222, v13
    v_add_f32 v223, v223, v14
    v_lshlrev_b32 v13, 16, v204
    v_and_b32 v14, 0xffff0000, v204
    v_add_f32 v216, v216, v13
    v_add_f32 v217, v217, v14
    v_lshlrev_b32 v13, 16, v205
    v_and_b32 v14, 0xffff0000, v205
    v_add_f32 v218, v218, v13
    v_add_f32 v219, v219, v14
    v_lshlrev_b32 v13, 16, v206
    v_and_b32 v14, 0xffff0000, v206
    v_add_f32 v220, v220, v13
    v_add_f32 v221, v221, v14
    v_lshlrev_b32 v13, 16, v207
    v_and_b32 v14, 0xffff0000, v207
    v_add_f32 v222, v222, v13
    v_add_f32 v223, v223, v14
    v_lshlrev_b32 v13, 16, v208
    v_and_b32 v14, 0xffff0000, v208
    v_add_f32 v216, v216, v13
    v_add_f32 v217, v217, v14
    v_lshlrev_b32 v13, 16, v209
    v_and_b32 v14, 0xffff0000, v209
    v_add_f32 v218, v218, v13
    v_add_f32 v219, v219, v14
    v_lshlrev_b32 v13, 16, v210
    v_and_b32 v14, 0xffff0000, v210
    v_add_f32 v220, v220, v13
    v_add_f32 v221, v221, v14
    v_lshlrev_b32 v13, 16, v211
    v_and_b32 v14, 0xffff0000, v211
    v_add_f32 v222, v222, v13
    v_add_f32 v223, v223, v14
    v_lshlrev_b32 v13, 16, v212
    v_and_b32 v14, 0xffff0000, v212
    v_add_f32 v216, v216, v13
    v_add_f32 v217, v217, v14
    v_lshlrev_b32 v13, 16, v213
    v_and_b32 v14, 0xffff0000, v213
    v_add_f32 v218, v218, v13
    v_add_f32 v219, v219, v14
    v_lshlrev_b32 v13, 16, v214
    v_and_b32 v14, 0xffff0000, v214
    v_add_f32 v220, v220, v13
    v_add_f32 v221, v221, v14
    v_lshlrev_b32 v13, 16, v215
    v_and_b32 v14, 0xffff0000, v215
    v_add_f32 v222, v222, v13
    v_add_f32 v223, v223, v14
    s_nop 1
    v_add_f32_dpp v216, v216, v216 row_ror:8 row_mask:0xf bank_mask:0xf
    v_add_f32_dpp v217, v217, v217 row_ror:8 row_mask:0xf bank_mask:0xf
    v_add_f32_dpp v218, v218, v218 row_ror:8 row_mask:0xf bank_mask:0xf
    v_add_f32_dpp v219, v219, v219 row_ror:8 row_mask:0xf bank_mask:0xf
    v_add_f32_dpp v220, v220, v220 row_ror:8 row_mask:0xf bank_mask:0xf
    v_add_f32_dpp v221, v221, v221 row_ror:8 row_mask:0xf bank_mask:0xf
    v_add_f32_dpp v222, v222, v222 row_ror:8 row_mask:0xf bank_mask:0xf
    v_add_f32_dpp v223, v223, v223 row_ror:8 row_mask:0xf bank_mask:0xf
    v_mov_b32 v224, v216
    v_mov_b32 v225, v217
    v_mov_b32 v226, v218
    v_mov_b32 v227, v219
    v_mov_b32 v228, v220
    v_mov_b32 v229, v221
    v_mov_b32 v230, v222
    v_mov_b32 v231, v223
    s_nop 1
    v_permlane16_swap_b32 v216, v224
    v_permlane16_swap_b32 v217, v225
    v_permlane16_swap_b32 v218, v226
    v_permlane16_swap_b32 v219, v227
    v_permlane16_swap_b32 v220, v228
    v_permlane16_swap_b32 v221, v229
    v_permlane16_swap_b32 v222, v230
    v_permlane16_swap_b32 v223, v231
    s_nop 1
    v_add_f32 v216, v216, v224
    v_add_f32 v217, v217, v225
    v_add_f32 v218, v218, v226
    v_add_f32 v219, v219, v227
    v_add_f32 v220, v220, v228
    v_add_f32 v221, v221, v229
    v_add_f32 v222, v222, v230
    v_add_f32 v223, v223, v231
    v_mov_b32 v224, v216
    v_mov_b32 v225, v217
    v_mov_b32 v226, v218
    v_mov_b32 v227, v219
    v_mov_b32 v228, v220
    v_mov_b32 v229, v221
    v_mov_b32 v230, v222
    v_mov_b32 v231, v223
    s_nop 1
    v_permlane32_swap_b32 v216, v224
    v_permlane32_swap_b32 v217, v225
    v_permlane32_swap_b32 v218, v226
    v_permlane32_swap_b32 v219, v227
    v_permlane32_swap_b32 v220, v228
    v_permlane32_swap_b32 v221, v229
    v_permlane32_swap_b32 v222, v230
    v_permlane32_swap_b32 v223, v231
    s_nop 1
    v_add_f32 v216, v216, v224
    v_add_f32 v217, v217, v225
    v_add_f32 v218, v218, v226
    v_add_f32 v219, v219, v227
    v_add_f32 v220, v220, v228
    v_add_f32 v221, v221, v229
    v_add_f32 v222, v222, v230
    v_add_f32 v223, v223, v231
    s_barrier
    ds_read_b32 v242, v241
    s_waitcnt lgkmcnt(0)
    v_readfirstlane_b32 s76, v242
    s_nop 1
    v_lshrrev_b32 v13, 3, v1
    v_mov_b32 v224, v216
    v_cmp_eq_u32 vcc, 1, v13
    s_nop 1
    v_cndmask_b32 v224, v224, v217, vcc
    v_cmp_eq_u32 vcc, 2, v13
    s_nop 1
    v_cndmask_b32 v224, v224, v218, vcc
    v_cmp_eq_u32 vcc, 3, v13
    s_nop 1
    v_cndmask_b32 v224, v224, v219, vcc
    v_cmp_eq_u32 vcc, 4, v13
    s_nop 1
    v_cndmask_b32 v224, v224, v220, vcc
    v_cmp_eq_u32 vcc, 5, v13
    s_nop 1
    v_cndmask_b32 v224, v224, v221, vcc
    v_cmp_eq_u32 vcc, 6, v13
    s_nop 1
    v_cndmask_b32 v224, v224, v222, vcc
    v_cmp_eq_u32 vcc, 7, v13
    s_nop 1
    v_cndmask_b32 v224, v224, v223, vcc
    v_mov_b32 v225, s76
    v_and_b32 v14, 7, v1
    v_lshl_add_u32 v13, v14, 3, v13
    s_lshr_b32 s33, s71, 2
    s_lshl_b32 s33, s33, 9
    s_and_b32 s34, s71, 3
    s_lshl_b32 s34, s34, 15
    s_add_u32 s33, s33, s34
    s_add_u32 s33, s33, 65536
    v_lshl_add_u32 v13, v13, 3, s33
    s_cmp_lt_u32 s71, 216
    s_cselect_b32 s33, 0, 0x40000000
    buffer_store_dwordx2 v[224:225], v13, s[60:63], s33 offen sc1
    s_add_u32 s16, s58, 0xc00000
    s_addc_u32 s17, s59, 0
    s_mov_b32 s18, 0x2a0000
    s_mov_b32 s19, 0x00020000
    s_cmp_lt_u32 s2, 128
    s_cselect_b32 s18, s18, 0
    s_lshl_b32 s32, s2, 6
    v_add_u32 v12, s32, v1
    v_lshrrev_b32 v13, 2, v12
    v_and_b32 v12, 3, v12
    v_mul_u32_u24 v13, 1344, v13
    v_mul_u32_u24 v12, 336, v12
    v_add_u32 v12, v12, v13
    v_mov_b32 v124, 0x3f803f80
    v_mov_b32 v125, 0x3f803f80
    v_mov_b32 v126, 0x3f803f80
    v_mov_b32 v127, 0x3f803f80
    buffer_store_dwordx4 v[124:127], v12, s[16:19], 0 offen offset:320
    s_cmp_eq_u32 s28, 3
    s_cbranch_scc1 k1_done
    s_barrier
    s_barrier
    s_endpgm
k1_done:
    s_endpgm
.text
.globl k2_kernel
.p2align 8
.type k2_kernel,@function
k2_kernel:
    s_cmp_ge_u32 s2, 256
    s_cbranch_scc1 k2_done
    s_load_dwordx2 s[6:7], s[0:1], 80
    s_load_dwordx4 s[76:79], s[0:1], 56
    s_load_dwordx2 s[4:5], s[0:1], 0
    v_lshrrev_b32 v1, 6, v0
    s_nop 0
    v_readfirstlane_b32 s64, v1
    s_and_b32 s32, s2, 7
    s_lshr_b32 s33, s2, 3
    s_lshl_b32 s34, s32, 2
    s_lshr_b32 s53, s33, 3
    s_add_u32 s34, s34, s53
    s_and_b32 s35, s33, 7
    s_lshl_b32 s52, s35, 3
    s_add_u32 s52, s52, s32
    s_and_b32 s65, s64, 3
    s_lshr_b32 s66, s64, 2
k2_restart:
    v_and_b32 v1, 63, v0
    v_lshlrev_b32 v47, 4, v1
    s_mul_i32 s46, s64, 3072
    s_mul_i32 s67, s34, 5
    s_lshr_b32 s67, s67, 1
    s_and_b32 s68, s34, 1
    s_mul_i32 s45, s66, 6656
    s_add_u32 s45, s45, 4096
    s_mul_i32 s69, s65, 3
    s_mul_i32 s70, s34, 86016
    s_add_u32 s70, s70, 3145728
    s_add_u32 s54, s69, 0
    s_lshr_b32 s55, s54, 2
    s_add_u32 s55, s55, s67
    s_lshl_b32 s55, s55, 15
    s_and_b32 s56, s54, 3
    s_lshl_b32 s56, s56, 10
    s_add_u32 s55, s55, s56
    s_lshl_b32 s56, s54, 10
    s_add_u32 s56, s56, s70
    s_cmp_eq_u32 s66, 0
    s_cselect_b32 s55, s55, s56
    v_add_u32 v12, s55, v47
    s_add_u32 s54, s69, 1
    s_lshr_b32 s55, s54, 2
    s_add_u32 s55, s55, s67
    s_lshl_b32 s55, s55, 15
    s_and_b32 s56, s54, 3
    s_lshl_b32 s56, s56, 10
    s_add_u32 s55, s55, s56
    s_lshl_b32 s56, s54, 10
    s_add_u32 s56, s56, s70
    s_cmp_eq_u32 s66, 0
    s_cselect_b32 s55, s55, s56
    s_sub_u32 s55, s55, 1024
    v_add_u32 v34, s55, v47
    s_add_u32 s54, s69, 2
    s_lshr_b32 s55, s54, 2
    s_add_u32 s55, s55, s67
    s_lshl_b32 s55, s55, 15
    s_and_b32 s56, s54, 3
    s_lshl_b32 s56, s56, 10
    s_add_u32 s55, s55, s56
    s_lshl_b32 s56, s54, 10
    s_add_u32 s56, s56, s70
    s_cmp_eq_u32 s54, 11
    s_cselect_b32 s56, 0x40000000, s56
    s_cmp_eq_u32 s66, 0
    s_cselect_b32 s55, s55, s56
    s_sub_u32 s55, s55, 2048
    v_add_u32 v35, s55, v47
    s_mov_b32 s51, 5898240
    s_mov_b32 s38, 0
    s_lshl_b32 s36, s35, 3
    s_lshl_b32 s37, s65, 1
    s_add_u32 s36, s36, s37
    s_add_u32 s36, s36, s66
    s_lshl_b32 s37, s36, 9
    s_lshl_b32 s54, s67, 15
    s_add_u32 s37, s37, s54
    s_xor_b32 s44, s37, 512
    v_and_b32 v2, 31, v1
    v_lshrrev_b32 v3, 5, v1
    v_add_u32 v7, s68, v3
    v_lshlrev_b32 v15, 4, v2
    v_lshl_add_u32 v4, v7, 12, v15
    v_lshl_add_u32 v40, v7, 15, v15
    s_lshl_b32 s54, s68, 1
    s_sub_u32 s54, 2, s54
    s_lshl_b32 s55, s68, 3
    s_lshl_b32 s56, s54, 12
    s_add_u32 s56, s56, s55
    v_add_u32 v5, s56, v15
    s_lshl_b32 s56, s54, 15
    s_add_u32 s56, s56, s55
    v_add_u32 v41, s56, v15
    v_mov_b32 v20, 0
    v_mov_b32 v21, 0
    v_mov_b32 v26, 0
    v_mov_b32 v27, 0
    v_mov_b32 v152, 0x3f803f80
    v_mov_b32 v153, 0x3f803f80
    v_mov_b32 v158, 0x3f803f80
    v_mov_b32 v159, 0x3f803f80
    s_xor_b32 s54, s65, 0
    s_lshl_b32 s54, s54, 10
    v_add_u32 v8, s54, v47
    s_xor_b32 s54, s65, 1
    s_lshl_b32 s54, s54, 10
    v_add_u32 v9, s54, v47
    s_xor_b32 s54, s65, 2
    s_lshl_b32 s54, s54, 10
    v_add_u32 v10, s54, v47
    s_xor_b32 s54, s65, 3
    s_lshl_b32 s54, s54, 10
    v_add_u32 v11, s54, v47
    s_waitcnt lgkmcnt(0)
    s_add_u32 s20, s6, 0x900000
    s_addc_u32 s21, s7, 0
    s_mov_b32 s22, 0x5a0000
    s_mov_b32 s23, 0x00020000
    s_add_u32 s8, s6, 0x600000
    s_addc_u32 s9, s7, 0
    s_mov_b32 s10, 0x280000
    s_mov_b32 s11, 0x00020000
    s_mov_b32 s47, 0
    s_add_u32 m0, s46, 0
    s_nop 0
    buffer_load_dwordx4 v12, s[20:23], s47 offen offset:0 lds
    buffer_load_dwordx4 v34, s[20:23], s47 offen offset:1024 lds
    buffer_load_dwordx4 v35, s[20:23], s47 offen offset:2048 lds
    s_add_u32 s47, s47, s45
    buffer_load_dwordx4 v[16:19], v40, s[8:11], s37 offen
    buffer_load_dwordx4 v[22:25], v40, s[8:11], s44 offen
    s_mov_b32 exec_hi, 0
    buffer_load_dwordx2 v[20:21], v41, s[8:11], s37 offen
    buffer_load_dwordx2 v[26:27], v41, s[8:11], s44 offen
    s_mov_b64 exec, -1
    s_add_u32 s12, s6, 0x1800000
    s_addc_u32 s13, s7, 0
    s_mov_b32 s14, 0x400000
    s_mov_b32 s15, 0x00020000
    s_load_dword s3, s[6:7], 0x80000
    v_mul_u32_u24 v15, 336, v3
    v_lshl_add_u32 v6, v2, 4, v15
    s_mul_i32 s57, s66, 1344
    s_add_u32 s57, s57, 12288
    v_add_u32 v6, s57, v6
    v_cmp_lt_u32 vcc, 20, v2
    v_mov_b32 v15, 262144
    s_lshl_b32 s57, s66, 9
    v_cndmask_b32 v6, v6, v15, vcc
    v_mov_b32 v7, 147456
    v_mov_b32 v15, 0
    ds_write_b32 v7, v15
    s_branch k2_main2
k2_main:
    s_mul_i32 s46, s64, 3072
    s_mov_b32 s22, s51
    s_mov_b32 s47, 0
    s_add_u32 m0, s46, 0
    s_nop 0
    buffer_load_dwordx4 v12, s[20:23], s47 offen offset:0 lds
    buffer_load_dwordx4 v34, s[20:23], s47 offen offset:1024 lds
    buffer_load_dwordx4 v35, s[20:23], s47 offen offset:2048 lds
    s_add_u32 s47, s47, s45
k2_main2:
    s_add_u32 s24, s6, 0x1000000
    s_addc_u32 s25, s7, 0
    s_mov_b32 s26, 0x600000
    s_mov_b32 s27, 0x00020000
    s_add_u32 s28, s6, 0x2000000
    s_addc_u32 s29, s7, 0
    s_mov_b32 s30, 0x1e0000
    s_mov_b32 s31, 0x00020000
    s_mul_i32 s54, s66, 48
    s_mul_i32 s48, s52, 96
    s_add_u32 s48, s48, s54
    s_lshl_b32 s48, s48, 10
    s_mul_i32 s49, s53, 5
    s_add_u32 s50, s49, 4
    s_add_u32 s49, s49, s65
    s_mul_i32 s49, s49, 96
    s_add_u32 s49, s49, s54
    s_lshl_b32 s49, s49, 10
    s_mul_i32 s50, s50, 96
    s_add_u32 s50, s50, s54
    s_lshl_b32 s50, s50, 10
    s_add_u32 s72, s6, 0x2400000
    s_addc_u32 s73, s7, 0
    s_mov_b32 s74, 0xc8000
    s_mov_b32 s75, 0x00020000
    s_mul_i32 s54, s66, 20
    s_mul_i32 s58, s53, 5
    s_add_u32 s59, s58, 4
    s_add_u32 s58, s58, s65
    s_mul_i32 s58, s58, 40
    s_add_u32 s58, s58, s54
    s_lshl_b32 s58, s58, 10
    s_mul_i32 s59, s59, 40
    s_add_u32 s59, s59, s54
    s_lshl_b32 s59, s59, 10
    s_mul_i32 s71, s64, 12288
    s_add_u32 s71, s71, 49152
    v_lshrrev_b32 v2, 4, v0
    v_and_b32 v3, 15, v0
    s_lshl_b32 s54, s52, 5
    s_mul_i32 s55, s53, 320
    v_lshl_add_u32 v42, v3, 4, s55
    v_add_u32 v13, s54, v2
    v_mul_u32_u24 v13, 1280, v13
    v_add_u32 v13, v13, v42
    v_lshrrev_b32 v2, 3, v0
    v_and_b32 v3, 7, v0
    s_add_u32 s55, s55, 256
    v_lshl_add_u32 v43, v3, 3, s55
    v_add_u32 v14, s54, v2
    v_mul_u32_u24 v14, 1280, v14
    v_add_u32 v14, v14, v43
    v_cmp_gt_u32 vcc, 256, v0
    v_mov_b32 v2, 0x7fffffff
    s_nop 0
    v_cndmask_b32 v14, v2, v14, vcc
    s_mov_b32 s8, s4
    s_mov_b32 s9, s5
    s_mov_b32 s10, 0x280000
    s_mov_b32 s11, 0x00020000
    s_mov_b32 s16, s76
    s_mov_b32 s17, s77
    s_mov_b32 s18, 0x500
    s_mov_b32 s19, 0x00020000
    v_mov_b32 v116, 0
    v_mov_b32 v117, 0
    v_mov_b32 v118, 0
    v_mov_b32 v119, 0
    v_mov_b32 v120, 0
    v_mov_b32 v121, 0
    v_mov_b32 v122, 0
    v_mov_b32 v123, 0
    v_mov_b32 v124, 0
    v_mov_b32 v125, 0
    v_mov_b32 v126, 0
    v_mov_b32 v127, 0
    v_mov_b32 v128, 0
    v_mov_b32 v129, 0
    v_mov_b32 v130, 0
    v_mov_b32 v131, 0
    v_mov_b32 v132, 0
    v_mov_b32 v133, 0
    v_mov_b32 v134, 0
    v_mov_b32 v135, 0
    v_mov_b32 v136, 0
    v_mov_b32 v137, 0
    v_mov_b32 v138, 0
    v_mov_b32 v139, 0
    v_mov_b32 v140, 0
    v_mov_b32 v141, 0
    v_mov_b32 v142, 0
    v_mov_b32 v143, 0
    v_mov_b32 v144, 0
    v_mov_b32 v145, 0
    v_mov_b32 v146, 0
    v_mov_b32 v147, 0
    v_mov_b32 v108, 0
    v_mov_b32 v109, 0
    v_mov_b32 v110, 0
    v_mov_b32 v111, 0
    v_mov_b32 v112, 0
    v_mov_b32 v113, 0
    v_mov_b32 v114, 0
    v_mov_b32 v115, 0
    v_mov_b32 v168, 0
    v_mov_b32 v169, 0
    v_mov_b32 v170, 0
    v_mov_b32 v171, 0
    v_mov_b32 v172, 0
    v_mov_b32 v173, 0
    v_mov_b32 v174, 0
    v_mov_b32 v175, 0
    v_mov_b32 v176, 0
    v_mov_b32 v177, 0
    v_mov_b32 v178, 0
    v_mov_b32 v179, 0
    v_mov_b32 v180, 0
    v_mov_b32 v181, 0
    v_mov_b32 v182, 0
    v_mov_b32 v183, 0
    v_mov_b32 v184, 0
    v_mov_b32 v185, 0
    v_mov_b32 v186, 0
    v_mov_b32 v187, 0
    v_mov_b32 v188, 0
    v_mov_b32 v189, 0
    v_mov_b32 v190, 0
    v_mov_b32 v191, 0
    v_mov_b32 v192, 0
    v_mov_b32 v193, 0
    v_mov_b32 v194, 0
    v_mov_b32 v195, 0
    v_mov_b32 v196, 0
    v_mov_b32 v197, 0
    v_mov_b32 v198, 0
    v_mov_b32 v199, 0
    v_mov_b32 v200, 0
    v_mov_b32 v201, 0
    v_mov_b32 v202, 0
    v_mov_b32 v203, 0
    v_mov_b32 v204, 0
    v_mov_b32 v205, 0
    v_mov_b32 v206, 0
    v_mov_b32 v207, 0
    s_waitcnt vmcnt(0) lgkmcnt(0)
    s_barrier
    s_cmp_lg_u32 s38, 0
    s_cbranch_scc1 k2_havemax
    ds_read_b128 v[154:157], v4 offset:0
    s_mov_b32 exec_hi, 0
    ds_read_b64 v[158:159], v5 offset:0
    s_mov_b32 exec_hi, -1
    v_add_u32 v4, s57, v4
    v_add_u32 v5, s57, v5
    ds_read_b128 v[148:151], v4 offset:0
    s_mov_b32 exec_hi, 0
    ds_read_b64 v[152:153], v5 offset:0
    s_mov_b32 exec_hi, -1
    ds_read_b128 v[160:163], v6 offset:0
    ds_read_b128 v[164:167], v6 offset:672
    buffer_load_dwordx4 v[208:211], v8, s[24:27], s48 offen
    buffer_load_dwordx4 v[212:215], v8, s[28:31], s49 offen
    s_waitcnt lgkmcnt(4)
    v_mfma_f32_32x32x16_bf16 v[68:83], v[154:157], v[16:19], 0
    v_mfma_f32_32x32x8_bf16 v[68:83], v[158:159], v[20:21], v[68:83]
    v_mfma_f32_32x32x16_bf16 v[84:99], v[154:157], v[22:25], 0
    v_mfma_f32_32x32x8_bf16 v[84:99], v[158:159], v[26:27], v[84:99]
    buffer_load_dwordx4 v[240:243], v8, s[28:31], s50 offen
    buffer_load_dwordx4 v[216:219], v9, s[24:27], s48 offen
    buffer_load_dwordx4 v[220:223], v9, s[28:31], s49 offen
    s_nop 6
    v_max3_f32 v2, v68, v69, v70
    v_max_f32 v2, v2, v71
    v_max3_f32 v2, v2, v72, v73
    v_max3_f32 v2, v2, v74, v75
    v_max3_f32 v2, v2, v76, v77
    v_max3_f32 v2, v2, v78, v79
    v_max3_f32 v2, v2, v80, v81
    v_max3_f32 v2, v2, v82, v83
    v_mov_b32 v7, v2
    s_nop 1
    v_permlane32_swap_b32 v2, v7
    s_nop 1
    v_max_f32 v2, v2, v7
    v_cvt_pk_bf16_f32 v7, -v2, -v2
    v_lshlrev_b32 v7, 16, v7
    v_sub_f32 v7, -v2, v7
    s_mov_b32 exec_lo, 0
    v_cvt_pk_bf16_f32 v20, -v2, v7
    s_mov_b64 exec, -1
    s_waitcnt lgkmcnt(0)
    v_mfma_f32_32x32x16_bf16 v[68:83], v[148:151], v[16:19], 0
    v_mfma_f32_32x32x8_bf16 v[68:83], v[152:153], v[20:21], v[68:83]
    s_add_u32 m0, s46, 24576
    s_nop 0
    buffer_load_dwordx4 v12, s[20:23], s47 offen offset:0 lds
    buffer_load_dwordx4 v34, s[20:23], s47 offen offset:1024 lds
    buffer_load_dwordx4 v35, s[20:23], s47 offen offset:2048 lds
    s_add_u32 s47, s47, s45
    v_max3_f32 v3, v84, v85, v86
    v_max_f32 v3, v3, v87
    v_max3_f32 v3, v3, v88, v89
    v_max3_f32 v3, v3, v90, v91
    v_max3_f32 v3, v3, v92, v93
    v_max3_f32 v3, v3, v94, v95
    v_max3_f32 v3, v3, v96, v97
    v_max3_f32 v3, v3, v98, v99
    v_mov_b32 v7, v3
    s_nop 1
    v_permlane32_swap_b32 v3, v7
    s_nop 1
    v_max_f32 v3, v3, v7
    v_cvt_pk_bf16_f32 v7, -v3, -v3
    v_lshlrev_b32 v7, 16, v7
    v_sub_f32 v7, -v3, v7
    s_mov_b32 exec_lo, 0
    v_cvt_pk_bf16_f32 v26, -v3, v7
    s_mov_b64 exec, -1
    buffer_load_dwordx4 v[224:227], v10, s[24:27], s48 offen
    buffer_load_dwordx4 v[228:231], v10, s[28:31], s49 offen
    s_branch k2_go
k2_havemax:
    ds_read_b128 v[148:151], v4 offset:0
    s_mov_b32 exec_hi, 0
    ds_read_b64 v[152:153], v5 offset:0
    s_mov_b32 exec_hi, -1
    ds_read_b128 v[160:163], v6 offset:0
    ds_read_b128 v[164:167], v6 offset:672
    buffer_load_dwordx4 v[208:211], v8, s[24:27], s48 offen
    buffer_load_dwordx4 v[212:215], v8, s[28:31], s49 offen
    buffer_load_dwordx4 v[240:243], v8, s[28:31], s50 offen
    buffer_load_dwordx4 v[216:219], v9, s[24:27], s48 offen
    buffer_load_dwordx4 v[220:223], v9, s[28:31], s49 offen
    s_add_u32 m0, s46, 24576
    s_nop 0
    buffer_load_dwordx4 v12, s[20:23], s47 offen offset:0 lds
    buffer_load_dwordx4 v34, s[20:23], s47 offen offset:1024 lds
    buffer_load_dwordx4 v35, s[20:23], s47 offen offset:2048 lds
    s_add_u32 s47, s47, s45
    buffer_load_dwordx4 v[224:227], v10, s[24:27], s48 offen
    buffer_load_dwordx4 v[228:231], v10, s[28:31], s49 offen
    s_waitcnt lgkmcnt(0)
    v_mfma_f32_32x32x16_bf16 v[68:83], v[148:151], v[16:19], 0
    v_mfma_f32_32x32x8_bf16 v[68:83], v[152:153], v[20:21], v[68:83]
    s_nop 10
k2_go:
    s_add_u32 s62, s58, 12288
    s_add_u32 s61, s66, 1
    s_mov_b32 s39, 0
    .p2align 3
k2_loop:
    s_cmp_eq_u32 s39, s61
    s_cbranch_scc1 k2_early
k2_early_ret:
    v_mfma_f32_32x32x16_bf16 v[84:99], v[148:151], v[22:25], 0
    ds_read_b128 v[154:157], v4 offset:1024
    s_mov_b32 exec_hi, 0
    ds_read_b64 v[158:159], v5 offset:1024
    s_mov_b32 exec_hi, -1
    v_exp_f32 v68, v68
    v_exp_f32 v69, v69
    v_exp_f32 v70, v70
    v_exp_f32 v71, v71
    v_cvt_pk_bf16_f32 v100, v68, v69
    v_mfma_f32_32x32x8_bf16 v[84:99], v[152:153], v[26:27], v[84:99]
    v_exp_f32 v72, v72
    v_exp_f32 v73, v73
    v_cvt_pk_bf16_f32 v101, v70, v71
    v_exp_f32 v74, v74
    v_exp_f32 v75, v75
    v_mfma_f32_32x32x16_bf16 v[132:147], v[168:171], v[108:111], v[132:147]
    v_cvt_pk_bf16_f32 v102, v72, v73
    v_exp_f32 v76, v76
    v_exp_f32 v77, v77
    v_cvt_pk_bf16_f32 v103, v74, v75
    v_exp_f32 v78, v78
    v_mfma_f32_32x32x16_bf16 v[132:147], v[172:175], v[112:115], v[132:147]
    v_exp_f32 v79, v79
    v_cvt_pk_bf16_f32 v104, v76, v77
    v_exp_f32 v80, v80
    v_exp_f32 v81, v81
    v_cvt_pk_bf16_f32 v105, v78, v79
    s_waitcnt vmcnt(8)
    v_mfma_f32_32x32x16_bf16 v[176:191], v[212:215], v[208:211], v[176:191]
    s_waitcnt lgkmcnt(0)
    v_exp_f32 v82, v82
    v_exp_f32 v83, v83
    v_cvt_pk_bf16_f32 v106, v80, v81
    v_cvt_pk_bf16_f32 v107, v82, v83
    v_mfma_f32_32x32x16_bf16 v[68:83], v[154:157], v[16:19], 0
    ds_read_b128 v[168:171], v6 offset:2688
    ds_read_b128 v[172:175], v6 offset:3360
    v_exp_f32 v84, v84
    v_exp_f32 v85, v85
    v_exp_f32 v86, v86
    v_exp_f32 v87, v87
    v_cvt_pk_bf16_f32 v108, v84, v85
    v_mfma_f32_32x32x8_bf16 v[68:83], v[158:159], v[20:21], v[68:83]
    v_exp_f32 v88, v88
    v_exp_f32 v89, v89
    v_cvt_pk_bf16_f32 v109, v86, v87
    v_exp_f32 v90, v90
    v_exp_f32 v91, v91
    v_mfma_f32_32x32x16_bf16 v[116:131], v[160:163], v[100:103], v[116:131]
    s_mov_b32 m0, s71
    s_add_u32 s71, s71, 1024
    buffer_load_dwordx4 v47, s[72:75], s58 offen lds
    s_add_u32 s58, s58, 1024
    v_cvt_pk_bf16_f32 v110, v88, v89
    v_exp_f32 v92, v92
    v_exp_f32 v93, v93
    v_cvt_pk_bf16_f32 v111, v90, v91
    v_exp_f32 v94, v94
    v_mfma_f32_32x32x16_bf16 v[116:131], v[164:167], v[104:107], v[116:131]
    v_exp_f32 v95, v95
    v_cvt_pk_bf16_f32 v112, v92, v93
    v_exp_f32 v96, v96
    v_exp_f32 v97, v97
    v_cvt_pk_bf16_f32 v113, v94, v95
    s_waitcnt vmcnt(8)
    v_mfma_f32_32x32x16_bf16 v[192:207], v[240:243], v[208:211], v[192:207]
    buffer_load_dwordx4 v[232:235], v11, s[24:27], s48 offen
    buffer_load_dwordx4 v[236:239], v11, s[28:31], s49 offen
    s_add_u32 s48, s48, 4096
    s_add_u32 s49, s49, 4096
    s_add_u32 s50, s50, 4096
    v_exp_f32 v98, v98
    v_exp_f32 v99, v99
    v_cvt_pk_bf16_f32 v114, v96, v97
    v_cvt_pk_bf16_f32 v115, v98, v99
    v_mfma_f32_32x32x16_bf16 v[84:99], v[154:157], v[22:25], 0
    ds_read_b128 v[148:151], v4 offset:2048
    s_mov_b32 exec_hi, 0
    ds_read_b64 v[152:153], v5 offset:2048
    s_mov_b32 exec_hi, -1
    v_exp_f32 v68, v68
    v_exp_f32 v69, v69
    v_exp_f32 v70, v70
    v_exp_f32 v71, v71
    v_cvt_pk_bf16_f32 v100, v68, v69
    v_mfma_f32_32x32x8_bf16 v[84:99], v[158:159], v[26:27], v[84:99]
    v_exp_f32 v72, v72
    v_exp_f32 v73, v73
    v_cvt_pk_bf16_f32 v101, v70, v71
    v_exp_f32 v74, v74
    v_exp_f32 v75, v75
    v_mfma_f32_32x32x16_bf16 v[132:147], v[160:163], v[108:111], v[132:147]
    v_cvt_pk_bf16_f32 v102, v72, v73
    v_exp_f32 v76, v76
    v_exp_f32 v77, v77
    v_cvt_pk_bf16_f32 v103, v74, v75
    v_exp_f32 v78, v78
    v_mfma_f32_32x32x16_bf16 v[132:147], v[164:167], v[112:115], v[132:147]
    v_exp_f32 v79, v79
    v_cvt_pk_bf16_f32 v104, v76, v77
    v_exp_f32 v80, v80
    v_exp_f32 v81, v81
    v_cvt_pk_bf16_f32 v105, v78, v79
    s_waitcnt vmcnt(8)
    v_mfma_f32_32x32x16_bf16 v[176:191], v[220:223], v[216:219], v[176:191]
    buffer_load_dwordx4 v[208:211], v8, s[24:27], s48 offen
    buffer_load_dwordx4 v[212:215], v8, s[28:31], s49 offen
    buffer_load_dwordx4 v[244:247], v8, s[28:31], s50 offen
    s_waitcnt lgkmcnt(0)
    v_exp_f32 v82, v82
    v_exp_f32 v83, v83
    v_cvt_pk_bf16_f32 v106, v80, v81
    v_cvt_pk_bf16_f32 v107, v82, v83
    v_mfma_f32_32x32x16_bf16 v[68:83], v[148:151], v[16:19], 0
    ds_read_b128 v[160:163], v6 offset:5376
    ds_read_b128 v[164:167], v6 offset:6048
    v_exp_f32 v84, v84
    v_exp_f32 v85, v85
    v_exp_f32 v86, v86
    v_exp_f32 v87, v87
    v_cvt_pk_bf16_f32 v108, v84, v85
    v_mfma_f32_32x32x8_bf16 v[68:83], v[152:153], v[20:21], v[68:83]
    v_exp_f32 v88, v88
    v_exp_f32 v89, v89
    v_cvt_pk_bf16_f32 v109, v86, v87
    v_exp_f32 v90, v90
    v_exp_f32 v91, v91
    v_mfma_f32_32x32x16_bf16 v[116:131], v[168:171], v[100:103], v[116:131]
    v_cvt_pk_bf16_f32 v110, v88, v89
    v_exp_f32 v92, v92
    v_exp_f32 v93, v93
    v_cvt_pk_bf16_f32 v111, v90, v91
    v_exp_f32 v94, v94
    v_mfma_f32_32x32x16_bf16 v[116:131], v[172:175], v[104:107], v[116:131]
    v_exp_f32 v95, v95
    v_cvt_pk_bf16_f32 v112, v92, v93
    v_exp_f32 v96, v96
    v_exp_f32 v97, v97
    v_cvt_pk_bf16_f32 v113, v94, v95
    s_waitcnt vmcnt(6)
    v_mfma_f32_32x32x16_bf16 v[176:191], v[228:231], v[224:227], v[176:191]
    buffer_load_dwordx4 v[216:219], v9, s[24:27], s48 offen
    buffer_load_dwordx4 v[220:223], v9, s[28:31], s49 offen
    v_exp_f32 v98, v98
    v_exp_f32 v99, v99
    v_cvt_pk_bf16_f32 v114, v96, v97
    v_cvt_pk_bf16_f32 v115, v98, v99
    v_mfma_f32_32x32x16_bf16 v[84:99], v[148:151], v[22:25], 0
    ds_read_b128 v[154:157], v4 offset:3072
    s_mov_b32 exec_hi, 0
    ds_read_b64 v[158:159], v5 offset:3072
    s_mov_b32 exec_hi, -1
    v_exp_f32 v68, v68
    v_exp_f32 v69, v69
    v_exp_f32 v70, v70
    v_exp_f32 v71, v71
    v_cvt_pk_bf16_f32 v100, v68, v69
    v_mfma_f32_32x32x8_bf16 v[84:99], v[152:153], v[26:27], v[84:99]
    v_exp_f32 v72, v72
    v_exp_f32 v73, v73
    v_cvt_pk_bf16_f32 v101, v70, v71
    v_exp_f32 v74, v74
    v_exp_f32 v75, v75
    v_mfma_f32_32x32x16_bf16 v[132:147], v[168:171], v[108:111], v[132:147]
    v_cvt_pk_bf16_f32 v102, v72, v73
    v_exp_f32 v76, v76
    v_exp_f32 v77, v77
    v_cvt_pk_bf16_f32 v103, v74, v75
    v_exp_f32 v78, v78
    v_mfma_f32_32x32x16_bf16 v[132:147], v[172:175], v[112:115], v[132:147]
    v_exp_f32 v79, v79
    v_cvt_pk_bf16_f32 v104, v76, v77
    v_exp_f32 v80, v80
    v_exp_f32 v81, v81
    v_cvt_pk_bf16_f32 v105, v78, v79
    s_waitcnt vmcnt(5)
    v_mfma_f32_32x32x16_bf16 v[176:191], v[236:239], v[232:235], v[176:191]
    buffer_load_dwordx4 v[224:227], v10, s[24:27], s48 offen
    buffer_load_dwordx4 v[228:231], v10, s[28:31], s49 offen
    s_waitcnt lgkmcnt(0)
    v_exp_f32 v82, v82
    v_exp_f32 v83, v83
    v_cvt_pk_bf16_f32 v106, v80, v81
    v_cvt_pk_bf16_f32 v107, v82, v83
    v_mfma_f32_32x32x16_bf16 v[68:83], v[154:157], v[16:19], 0
    ds_read_b128 v[168:171], v6 offset:8064
    ds_read_b128 v[172:175], v6 offset:8736
    v_exp_f32 v84, v84
    v_exp_f32 v85, v85
    v_exp_f32 v86, v86
    v_exp_f32 v87, v87
    v_cvt_pk_bf16_f32 v108, v84, v85
    v_mfma_f32_32x32x8_bf16 v[68:83], v[158:159], v[20:21], v[68:83]
    v_exp_f32 v88, v88
    v_exp_f32 v89, v89
    v_cvt_pk_bf16_f32 v109, v86, v87
    v_exp_f32 v90, v90
    v_exp_f32 v91, v91
    v_mfma_f32_32x32x16_bf16 v[116:131], v[160:163], v[100:103], v[116:131]
    s_mov_b32 m0, s71
    s_add_u32 s71, s71, 1024
    buffer_load_dwordx4 v47, s[72:75], s58 offen lds
    s_add_u32 s58, s58, 1024
    v_cvt_pk_bf16_f32 v110, v88, v89
    v_exp_f32 v92, v92
    v_exp_f32 v93, v93
    v_cvt_pk_bf16_f32 v111, v90, v91
    v_exp_f32 v94, v94
    v_mfma_f32_32x32x16_bf16 v[116:131], v[164:167], v[104:107], v[116:131]
    v_exp_f32 v95, v95
    v_cvt_pk_bf16_f32 v112, v92, v93
    v_exp_f32 v96, v96
    v_exp_f32 v97, v97
    v_cvt_pk_bf16_f32 v113, v94, v95
    s_waitcnt vmcnt(6)
    v_mfma_f32_32x32x16_bf16 v[176:191], v[212:215], v[208:211], v[176:191]
    v_exp_f32 v98, v98
    v_exp_f32 v99, v99
    v_cvt_pk_bf16_f32 v114, v96, v97
    v_cvt_pk_bf16_f32 v115, v98, v99
    v_mfma_f32_32x32x16_bf16 v[84:99], v[154:157], v[22:25], 0
    s_waitcnt vmcnt(13)
    s_waitcnt lgkmcnt(0)
    s_barrier
    ds_read_b128 v[148:151], v4 offset:24576
    s_mov_b32 exec_hi, 0
    ds_read_b64 v[152:153], v5 offset:24576
    s_mov_b32 exec_hi, -1
    v_exp_f32 v68, v68
    v_exp_f32 v69, v69
    v_exp_f32 v70, v70
    v_exp_f32 v71, v71
    v_cvt_pk_bf16_f32 v100, v68, v69
    v_mfma_f32_32x32x8_bf16 v[84:99], v[158:159], v[26:27], v[84:99]
    v_exp_f32 v72, v72
    v_exp_f32 v73, v73
    v_cvt_pk_bf16_f32 v101, v70, v71
    v_exp_f32 v74, v74
    v_exp_f32 v75, v75
    v_mfma_f32_32x32x16_bf16 v[132:147], v[160:163], v[108:111], v[132:147]
    s_cmp_lt_u32 s39, 3
    s_cselect_b32 s22, s22, 0
    s_cselect_b32 s46, s46, 0x30000
    s_add_u32 m0, s46, 0
    s_nop 0
    buffer_load_dwordx4 v12, s[20:23], s47 offen offset:0 lds
    buffer_load_dwordx4 v34, s[20:23], s47 offen offset:1024 lds
    buffer_load_dwordx4 v35, s[20:23], s47 offen offset:2048 lds
    s_add_u32 s47, s47, s45
    v_cvt_pk_bf16_f32 v102, v72, v73
    v_exp_f32 v76, v76
    v_exp_f32 v77, v77
    v_cvt_pk_bf16_f32 v103, v74, v75
    v_exp_f32 v78, v78
    v_mfma_f32_32x32x16_bf16 v[132:147], v[164:167], v[112:115], v[132:147]
    v_exp_f32 v79, v79
    v_cvt_pk_bf16_f32 v104, v76, v77
    v_exp_f32 v80, v80
    v_exp_f32 v81, v81
    v_cvt_pk_bf16_f32 v105, v78, v79
    s_waitcnt vmcnt(8)
    v_mfma_f32_32x32x16_bf16 v[192:207], v[244:247], v[208:211], v[192:207]
    buffer_load_dwordx4 v[232:235], v11, s[24:27], s48 offen
    buffer_load_dwordx4 v[236:239], v11, s[28:31], s49 offen
    s_add_u32 s48, s48, 4096
    s_add_u32 s49, s49, 4096
    s_add_u32 s50, s50, 4096
    s_waitcnt lgkmcnt(0)
    v_exp_f32 v82, v82
    v_exp_f32 v83, v83
    v_cvt_pk_bf16_f32 v106, v80, v81
    v_cvt_pk_bf16_f32 v107, v82, v83
    v_mfma_f32_32x32x16_bf16 v[68:83], v[148:151], v[16:19], 0
    ds_read_b128 v[160:163], v6 offset:24576
    ds_read_b128 v[164:167], v6 offset:25248
    v_exp_f32 v84, v84
    v_exp_f32 v85, v85
    v_exp_f32 v86, v86
    v_exp_f32 v87, v87
    v_cvt_pk_bf16_f32 v108, v84, v85
    v_mfma_f32_32x32x8_bf16 v[68:83], v[152:153], v[20:21], v[68:83]
    v_exp_f32 v88, v88
    v_exp_f32 v89, v89
    v_cvt_pk_bf16_f32 v109, v86, v87
    v_exp_f32 v90, v90
    v_exp_f32 v91, v91
    v_mfma_f32_32x32x16_bf16 v[116:131], v[168:171], v[100:103], v[116:131]
    v_cvt_pk_bf16_f32 v110, v88, v89
    v_exp_f32 v92, v92
    v_exp_f32 v93, v93
    v_cvt_pk_bf16_f32 v111, v90, v91
    v_exp_f32 v94, v94
    v_mfma_f32_32x32x16_bf16 v[116:131], v[172:175], v[104:107], v[116:131]
    v_exp_f32 v95, v95
    v_cvt_pk_bf16_f32 v112, v92, v93
    v_exp_f32 v96, v96
    v_exp_f32 v97, v97
    v_cvt_pk_bf16_f32 v113, v94, v95
    s_waitcnt vmcnt(8)
    v_mfma_f32_32x32x16_bf16 v[176:191], v[220:223], v[216:219], v[176:191]
    buffer_load_dwordx4 v[208:211], v8, s[24:27], s48 offen
    buffer_load_dwordx4 v[212:215], v8, s[28:31], s49 offen
    buffer_load_dwordx4 v[240:243], v8, s[28:31], s50 offen
    v_exp_f32 v98, v98
    v_exp_f32 v99, v99
    v_cvt_pk_bf16_f32 v114, v96, v97
    v_cvt_pk_bf16_f32 v115, v98, v99
    v_mfma_f32_32x32x16_bf16 v[84:99], v[148:151], v[22:25], 0
    ds_read_b128 v[154:157], v4 offset:25600
    s_mov_b32 exec_hi, 0
    ds_read_b64 v[158:159], v5 offset:25600
    s_mov_b32 exec_hi, -1
    v_exp_f32 v68, v68
    v_exp_f32 v69, v69
    v_exp_f32 v70, v70
    v_exp_f32 v71, v71
    v_cvt_pk_bf16_f32 v100, v68, v69
    v_mfma_f32_32x32x8_bf16 v[84:99], v[152:153], v[26:27], v[84:99]
    v_exp_f32 v72, v72
    v_exp_f32 v73, v73
    v_cvt_pk_bf16_f32 v101, v70, v71
    v_exp_f32 v74, v74
    v_exp_f32 v75, v75
    v_mfma_f32_32x32x16_bf16 v[132:147], v[168:171], v[108:111], v[132:147]
    v_cvt_pk_bf16_f32 v102, v72, v73
    v_exp_f32 v76, v76
    v_exp_f32 v77, v77
    v_cvt_pk_bf16_f32 v103, v74, v75
    v_exp_f32 v78, v78
    v_mfma_f32_32x32x16_bf16 v[132:147], v[172:175], v[112:115], v[132:147]
    v_exp_f32 v79, v79
    v_cvt_pk_bf16_f32 v104, v76, v77
    v_exp_f32 v80, v80
    v_exp_f32 v81, v81
    v_cvt_pk_bf16_f32 v105, v78, v79
    s_waitcnt vmcnt(9)
    v_mfma_f32_32x32x16_bf16 v[176:191], v[228:231], v[224:227], v[176:191]
    buffer_load_dwordx4 v[216:219], v9, s[24:27], s48 offen
    buffer_load_dwordx4 v[220:223], v9, s[28:31], s49 offen
    s_waitcnt lgkmcnt(0)
    v_exp_f32 v82, v82
    v_exp_f32 v83, v83
    v_cvt_pk_bf16_f32 v106, v80, v81
    v_cvt_pk_bf16_f32 v107, v82, v83
    v_mfma_f32_32x32x16_bf16 v[68:83], v[154:157], v[16:19], 0
    ds_read_b128 v[168:171], v6 offset:27264
    ds_read_b128 v[172:175], v6 offset:27936
    v_exp_f32 v84, v84
    v_exp_f32 v85, v85
    v_exp_f32 v86, v86
    v_exp_f32 v87, v87
    v_cvt_pk_bf16_f32 v108, v84, v85
    v_mfma_f32_32x32x8_bf16 v[68:83], v[158:159], v[20:21], v[68:83]
    v_exp_f32 v88, v88
    v_exp_f32 v89, v89
    v_cvt_pk_bf16_f32 v109, v86, v87
    v_exp_f32 v90, v90
    v_exp_f32 v91, v91
    v_mfma_f32_32x32x16_bf16 v[116:131], v[160:163], v[100:103], v[116:131]
    s_mov_b32 m0, s71
    s_add_u32 s71, s71, 1024
    buffer_load_dwordx4 v47, s[72:75], s58 offen lds
    s_add_u32 s58, s58, 1024
    v_cvt_pk_bf16_f32 v110, v88, v89
    v_exp_f32 v92, v92
    v_exp_f32 v93, v93
    v_cvt_pk_bf16_f32 v111, v90, v91
    v_exp_f32 v94, v94
    v_mfma_f32_32x32x16_bf16 v[116:131], v[164:167], v[104:107], v[116:131]
    v_exp_f32 v95, v95
    v_cvt_pk_bf16_f32 v112, v92, v93
    v_exp_f32 v96, v96
    v_exp_f32 v97, v97
    v_cvt_pk_bf16_f32 v113, v94, v95
    s_waitcnt vmcnt(6)
    v_mfma_f32_32x32x16_bf16 v[176:191], v[236:239], v[232:235], v[176:191]
    buffer_load_dwordx4 v[224:227], v10, s[24:27], s48 offen
    buffer_load_dwordx4 v[228:231], v10, s[28:31], s49 offen
    v_exp_f32 v98, v98
    v_exp_f32 v99, v99
    v_cvt_pk_bf16_f32 v114, v96, v97
    v_cvt_pk_bf16_f32 v115, v98, v99
    v_mfma_f32_32x32x16_bf16 v[84:99], v[154:157], v[22:25], 0
    ds_read_b128 v[148:151], v4 offset:26624
    s_mov_b32 exec_hi, 0
    ds_read_b64 v[152:153], v5 offset:26624
    s_mov_b32 exec_hi, -1
    v_exp_f32 v68, v68
    v_exp_f32 v69, v69
    v_exp_f32 v70, v70
    v_exp_f32 v71, v71
    v_cvt_pk_bf16_f32 v100, v68, v69
    v_mfma_f32_32x32x8_bf16 v[84:99], v[158:159], v[26:27], v[84:99]
    v_exp_f32 v72, v72
    v_exp_f32 v73, v73
    v_cvt_pk_bf16_f32 v101, v70, v71
    v_exp_f32 v74, v74
    v_exp_f32 v75, v75
    v_mfma_f32_32x32x16_bf16 v[132:147], v[160:163], v[108:111], v[132:147]
    v_cvt_pk_bf16_f32 v102, v72, v73
    v_exp_f32 v76, v76
    v_exp_f32 v77, v77
    v_cvt_pk_bf16_f32 v103, v74, v75
    v_exp_f32 v78, v78
    v_mfma_f32_32x32x16_bf16 v[132:147], v[164:167], v[112:115], v[132:147]
    v_exp_f32 v79, v79
    v_cvt_pk_bf16_f32 v104, v76, v77
    v_exp_f32 v80, v80
    v_exp_f32 v81, v81
    v_cvt_pk_bf16_f32 v105, v78, v79
    s_waitcnt vmcnt(6)
    v_mfma_f32_32x32x16_bf16 v[176:191], v[212:215], v[208:211], v[176:191]
    s_waitcnt lgkmcnt(0)
    v_exp_f32 v82, v82
    v_exp_f32 v83, v83
    v_cvt_pk_bf16_f32 v106, v80, v81
    v_cvt_pk_bf16_f32 v107, v82, v83
    v_mfma_f32_32x32x16_bf16 v[68:83], v[148:151], v[16:19], 0
    ds_read_b128 v[160:163], v6 offset:29952
    ds_read_b128 v[164:167], v6 offset:30624
    v_exp_f32 v84, v84
    v_exp_f32 v85, v85
    v_exp_f32 v86, v86
    v_exp_f32 v87, v87
    v_cvt_pk_bf16_f32 v108, v84, v85
    v_mfma_f32_32x32x8_bf16 v[68:83], v[152:153], v[20:21], v[68:83]
    v_exp_f32 v88, v88
    v_exp_f32 v89, v89
    v_cvt_pk_bf16_f32 v109, v86, v87
    v_exp_f32 v90, v90
    v_exp_f32 v91, v91
    v_mfma_f32_32x32x16_bf16 v[116:131], v[168:171], v[100:103], v[116:131]
    v_cvt_pk_bf16_f32 v110, v88, v89
    v_exp_f32 v92, v92
    v_exp_f32 v93, v93
    v_cvt_pk_bf16_f32 v111, v90, v91
    v_exp_f32 v94, v94
    v_mfma_f32_32x32x16_bf16 v[116:131], v[172:175], v[104:107], v[116:131]
    v_exp_f32 v95, v95
    v_cvt_pk_bf16_f32 v112, v92, v93
    v_exp_f32 v96, v96
    v_exp_f32 v97, v97
    v_cvt_pk_bf16_f32 v113, v94, v95
    s_waitcnt vmcnt(5)
    v_mfma_f32_32x32x16_bf16 v[192:207], v[240:243], v[208:211], v[192:207]
    buffer_load_dwordx4 v[232:235], v11, s[24:27], s48 offen
    buffer_load_dwordx4 v[236:239], v11, s[28:31], s49 offen
    s_add_u32 s48, s48, 4096
    s_add_u32 s49, s49, 4096
    s_add_u32 s50, s50, 4096
    v_exp_f32 v98, v98
    v_exp_f32 v99, v99
    v_cvt_pk_bf16_f32 v114, v96, v97
    v_cvt_pk_bf16_f32 v115, v98, v99
    v_mfma_f32_32x32x16_bf16 v[84:99], v[148:151], v[22:25], 0
    ds_read_b128 v[154:157], v4 offset:27648
    s_mov_b32 exec_hi, 0
    ds_read_b64 v[158:159], v5 offset:27648
    s_mov_b32 exec_hi, -1
    v_exp_f32 v68, v68
    v_exp_f32 v69, v69
    v_exp_f32 v70, v70
    v_exp_f32 v71, v71
    v_cvt_pk_bf16_f32 v100, v68, v69
    v_mfma_f32_32x32x8_bf16 v[84:99], v[152:153], v[26:27], v[84:99]
    v_exp_f32 v72, v72
    v_exp_f32 v73, v73
    v_cvt_pk_bf16_f32 v101, v70, v71
    v_exp_f32 v74, v74
    v_exp_f32 v75, v75
    v_mfma_f32_32x32x16_bf16 v[132:147], v[168:171], v[108:111], v[132:147]
    v_cvt_pk_bf16_f32 v102, v72, v73
    v_exp_f32 v76, v76
    v_exp_f32 v77, v77
    v_cvt_pk_bf16_f32 v103, v74, v75
    v_exp_f32 v78, v78
    v_mfma_f32_32x32x16_bf16 v[132:147], v[172:175], v[112:115], v[132:147]
    v_exp_f32 v79, v79
    v_cvt_pk_bf16_f32 v104, v76, v77
    v_exp_f32 v80, v80
    v_exp_f32 v81, v81
    v_cvt_pk_bf16_f32 v105, v78, v79
    s_waitcnt vmcnt(5)
    v_mfma_f32_32x32x16_bf16 v[176:191], v[220:223], v[216:219], v[176:191]
    s_add_u32 s60, s58, 4096
    s_cmp_lt_u32 s39, 3
    s_cselect_b32 s24, s24, s72
    s_cselect_b32 s25, s25, s73
    s_cselect_b32 s26, s26, s74
    s_cselect_b32 s28, s28, s72
    s_cselect_b32 s29, s29, s73
    s_cselect_b32 s30, s30, s74
    s_cselect_b32 s48, s48, s60
    s_cselect_b32 s49, s49, s58
    s_cselect_b32 s50, s50, 0x40000000
    buffer_load_dwordx4 v[208:211], v8, s[24:27], s48 offen
    buffer_load_dwordx4 v[212:215], v8, s[28:31], s49 offen
    buffer_load_dwordx4 v[240:243], v8, s[28:31], s50 offen
    s_waitcnt lgkmcnt(0)
    v_exp_f32 v82, v82
    v_exp_f32 v83, v83
    v_cvt_pk_bf16_f32 v106, v80, v81
    v_cvt_pk_bf16_f32 v107, v82, v83
    v_mfma_f32_32x32x16_bf16 v[68:83], v[154:157], v[16:19], 0
    ds_read_b128 v[168:171], v6 offset:32640
    ds_read_b128 v[172:175], v6 offset:33312
    v_exp_f32 v84, v84
    v_exp_f32 v85, v85
    v_exp_f32 v86, v86
    v_exp_f32 v87, v87
    v_cvt_pk_bf16_f32 v108, v84, v85
    v_mfma_f32_32x32x8_bf16 v[68:83], v[158:159], v[20:21], v[68:83]
    v_exp_f32 v88, v88
    v_exp_f32 v89, v89
    v_cvt_pk_bf16_f32 v109, v86, v87
    v_exp_f32 v90, v90
    v_exp_f32 v91, v91
    v_mfma_f32_32x32x16_bf16 v[116:131], v[160:163], v[100:103], v[116:131]
    v_cvt_pk_bf16_f32 v110, v88, v89
    v_exp_f32 v92, v92
    v_exp_f32 v93, v93
    v_cvt_pk_bf16_f32 v111, v90, v91
    v_exp_f32 v94, v94
    v_mfma_f32_32x32x16_bf16 v[116:131], v[164:167], v[104:107], v[116:131]
    v_exp_f32 v95, v95
    v_cvt_pk_bf16_f32 v112, v92, v93
    v_exp_f32 v96, v96
    v_exp_f32 v97, v97
    v_cvt_pk_bf16_f32 v113, v94, v95
    s_waitcnt vmcnt(5)
    v_mfma_f32_32x32x16_bf16 v[176:191], v[228:231], v[224:227], v[176:191]
    buffer_load_dwordx4 v[216:219], v9, s[24:27], s48 offen
    buffer_load_dwordx4 v[220:223], v9, s[28:31], s49 offen
    v_exp_f32 v98, v98
    v_exp_f32 v99, v99
    v_cvt_pk_bf16_f32 v114, v96, v97
    v_cvt_pk_bf16_f32 v115, v98, v99
    v_mfma_f32_32x32x16_bf16 v[84:99], v[154:157], v[22:25], 0
    s_waitcnt vmcnt(17)
    s_waitcnt lgkmcnt(0)
    s_barrier
    ds_read_b128 v[148:151], v4 offset:0
    s_mov_b32 exec_hi, 0
    ds_read_b64 v[152:153], v5 offset:0
    s_mov_b32 exec_hi, -1
    v_exp_f32 v68, v68
    v_exp_f32 v69, v69
    v_exp_f32 v70, v70
    v_exp_f32 v71, v71
    v_cvt_pk_bf16_f32 v100, v68, v69
    v_mfma_f32_32x32x8_bf16 v[84:99], v[158:159], v[26:27], v[84:99]
    v_exp_f32 v72, v72
    v_exp_f32 v73, v73
    v_cvt_pk_bf16_f32 v101, v70, v71
    v_exp_f32 v74, v74
    v_exp_f32 v75, v75
    v_mfma_f32_32x32x16_bf16 v[132:147], v[160:163], v[108:111], v[132:147]
    s_cmp_lt_u32 s39, 3
    s_cselect_b32 s22, s22, 0
    s_cselect_b32 s46, s46, 0x30000
    s_add_u32 m0, s46, 24576
    s_nop 0
    buffer_load_dwordx4 v12, s[20:23], s47 offen offset:0 lds
    buffer_load_dwordx4 v34, s[20:23], s47 offen offset:1024 lds
    buffer_load_dwordx4 v35, s[20:23], s47 offen offset:2048 lds
    s_add_u32 s47, s47, s45
    v_cvt_pk_bf16_f32 v102, v72, v73
    v_exp_f32 v76, v76
    v_exp_f32 v77, v77
    v_cvt_pk_bf16_f32 v103, v74, v75
    v_exp_f32 v78, v78
    v_mfma_f32_32x32x16_bf16 v[132:147], v[164:167], v[112:115], v[132:147]
    v_exp_f32 v79, v79
    v_cvt_pk_bf16_f32 v104, v76, v77
    v_exp_f32 v80, v80
    v_exp_f32 v81, v81
    v_cvt_pk_bf16_f32 v105, v78, v79
    s_waitcnt vmcnt(8)
    v_mfma_f32_32x32x16_bf16 v[176:191], v[236:239], v[232:235], v[176:191]
    buffer_load_dwordx4 v[224:227], v10, s[24:27], s48 offen
    buffer_load_dwordx4 v[228:231], v10, s[28:31], s49 offen
    s_waitcnt lgkmcnt(0)
    v_exp_f32 v82, v82
    v_exp_f32 v83, v83
    v_cvt_pk_bf16_f32 v106, v80, v81
    v_cvt_pk_bf16_f32 v107, v82, v83
    v_mfma_f32_32x32x16_bf16 v[68:83], v[148:151], v[16:19], 0
    ds_read_b128 v[160:163], v6 offset:0
    ds_read_b128 v[164:167], v6 offset:672
    v_exp_f32 v84, v84
    v_exp_f32 v85, v85
    v_exp_f32 v86, v86
    v_exp_f32 v87, v87
    v_cvt_pk_bf16_f32 v108, v84, v85
    v_mfma_f32_32x32x8_bf16 v[68:83], v[152:153], v[20:21], v[68:83]
    v_exp_f32 v88, v88
    v_exp_f32 v89, v89
    v_cvt_pk_bf16_f32 v109, v86, v87
    v_exp_f32 v90, v90
    v_exp_f32 v91, v91
    v_mfma_f32_32x32x16_bf16 v[116:131], v[168:171], v[100:103], v[116:131]
    v_cvt_pk_bf16_f32 v110, v88, v89
    v_exp_f32 v92, v92
    v_exp_f32 v93, v93
    v_cvt_pk_bf16_f32 v111, v90, v91
    v_exp_f32 v94, v94
    v_mfma_f32_32x32x16_bf16 v[116:131], v[172:175], v[104:107], v[116:131]
    v_exp_f32 v95, v95
    v_cvt_pk_bf16_f32 v112, v92, v93
    v_exp_f32 v96, v96
    v_exp_f32 v97, v97
    v_cvt_pk_bf16_f32 v113, v94, v95
    s_add_u32 s39, s39, 1
    s_cmp_lt_u32 s39, 4
    v_exp_f32 v98, v98
    v_exp_f32 v99, v99
    v_cvt_pk_bf16_f32 v114, v96, v97
    v_cvt_pk_bf16_f32 v115, v98, v99
    s_cbranch_scc1 k2_loop
    s_nop 1
    v_mfma_f32_32x32x16_bf16 v[132:147], v[168:171], v[108:111], v[132:147]
    v_mfma_f32_32x32x16_bf16 v[132:147], v[172:175], v[112:115], v[132:147]
    s_mul_i32 s40, s64, 3072
    s_add_u32 s40, s40, 0
    v_add_u32 v7, s40, v47
    s_xor_b32 s40, s64, 4
    s_mul_i32 s40, s40, 3072
    s_add_u32 s40, s40, 0
    v_add_u32 v15, s40, v47
    s_lshl_b32 s41, s36, 5
    s_add_u32 s41, s41, s34
    s_lshl_b32 s41, s41, 11
    s_nop 7
    ds_write_b128 v7, v[132:135] offset:0
    ds_write_b128 v7, v[136:139] offset:1024
    ds_write_b128 v7, v[140:143] offset:2048
    s_mov_b32 s40, 0x5f800000
    s_waitcnt lgkmcnt(0)
    s_barrier
    ds_read_b128 v[68:71], v15 offset:0
    ds_read_b128 v[72:75], v15 offset:1024
    ds_read_b128 v[76:79], v15 offset:2048
    v_mov_b32 v44, 0
    v_mov_b32 v45, 0
    v_mov_b32 v2, 0
    v_mov_b32 v3, 0
    s_waitcnt lgkmcnt(0)
    v_pk_add_f32 v[124:125], v[124:125], v[76:77]
    v_pk_add_f32 v[126:127], v[126:127], v[78:79]
    v_mov_b32 v7, v124
    v_mov_b32 v46, v124
    v_pk_add_f32 v[116:117], v[116:117], v[68:69]
    v_pk_add_f32 v[118:119], v[118:119], v[70:71]
    v_pk_add_f32 v[120:121], v[120:121], v[72:73]
    v_pk_add_f32 v[122:123], v[122:123], v[74:75]
    v_permlane32_swap_b32 v7, v46
    v_pk_fma_f32 v[2:3], v[116:117], v[44:45], v[2:3]
    v_pk_fma_f32 v[2:3], v[118:119], v[44:45], v[2:3]
    v_pk_fma_f32 v[2:3], v[120:121], v[44:45], v[2:3]
    v_pk_fma_f32 v[2:3], v[122:123], v[44:45], v[2:3]
    v_pk_fma_f32 v[2:3], v[124:125], v[44:45], v[2:3]
    v_pk_fma_f32 v[2:3], v[126:127], v[44:45], v[2:3]
    v_cmp_nlt_f32 s[60:61], v46, s40
    v_cmp_u_f32 s[62:63], v2, v3
    v_rcp_f32 v46, v46
    s_nop 2
    s_or_b64 s[60:61], s[60:61], s[62:63]
    s_cbranch_scc0 k2_noflag
    v_mov_b32 v7, 147456
    v_mov_b32 v15, 1
    ds_write_b32 v7, v15
    s_cmp_eq_u32 s38, 0
    s_cbranch_scc1 k2_nopub
k2_noflag:
    v_pk_mul_f32 v[116:117], v[116:117], v[46:47] op_sel_hi:[1,0]
    v_pk_mul_f32 v[118:119], v[118:119], v[46:47] op_sel_hi:[1,0]
    v_pk_mul_f32 v[120:121], v[120:121], v[46:47] op_sel_hi:[1,0]
    v_pk_mul_f32 v[122:123], v[122:123], v[46:47] op_sel_hi:[1,0]
    v_pk_mul_f32 v[124:125], v[124:125], v[46:47] op_sel_hi:[1,0]
    v_pk_mul_f32 v[126:127], v[126:127], v[46:47] op_sel_hi:[1,0]
    v_cvt_pk_bf16_f32 v168, v116, v117
    v_cvt_pk_bf16_f32 v169, v118, v119
    v_cvt_pk_bf16_f32 v170, v120, v121
    v_cvt_pk_bf16_f32 v174, v122, v123
    v_cvt_pk_bf16_f32 v172, v124, v125
    v_cvt_pk_bf16_f32 v173, v126, v127
    v_mov_b32 v171, s3
    v_mov_b32 v175, s3
    buffer_store_dwordx4 v[168:171], v47, s[12:15], s41 offen sc1
    buffer_store_dwordx4 v[172:175], v47, s[12:15], s41 offen offset:1024 sc1
k2_nopub:
    v_mov_b32 v7, 147460
    v_mov_b32 v15, 0
    ds_write_b32 v7, v15
    s_waitcnt lgkmcnt(0)
    s_barrier
    v_mov_b32 v7, 147456
    ds_read_b32 v15, v7
    s_lshl_b32 s40, s52, 5
    s_lshl_b32 s41, s64, 2
    s_add_u32 s40, s40, s41
    s_lshl_b32 s40, s40, 11
    v_add_u32 v3, 4096, v47
    v_and_b32 v2, 3, v1
    v_lshlrev_b32 v2, 11, v2
    v_add_u32 v2, 2044, v2
    s_waitcnt lgkmcnt(0)
    v_readfirstlane_b32 s41, v15
    s_nop 3
    s_cmp_eq_u32 s41, 0
    s_cbranch_scc1 k2_pub
    s_cmp_eq_u32 s38, 0
    s_cbranch_scc1 k2_fallback
k2_pub:
    s_mov_b32 s41, 0
k2_poll:
    s_add_u32 s41, s41, 1
    s_branch k2_full
    s_mov_b64 exec, 15
    buffer_load_dword v15, v2, s[12:15], s40 offen sc1
    s_waitcnt vmcnt(0)
    v_cmp_ne_u32 vcc, s3, v15
    s_mov_b64 exec, -1
    s_add_u32 s41, s41, 1
    s_nop 2
    s_cmp_eq_u32 vcc_lo, 0
    s_cbranch_scc1 k2_full
    s_cmp_lt_u32 s41, 400
    s_cbranch_scc1 k2_poll
    s_branch k2_miss
k2_full:
    buffer_load_dwordx4 v[68:71], v47, s[12:15], s40 offen offset:0 sc1
    buffer_load_dwordx4 v[72:75], v47, s[12:15], s40 offen offset:1024 sc1
    buffer_load_dwordx4 v[76:79], v47, s[12:15], s40 offen offset:2048 sc1
    buffer_load_dwordx4 v[80:83], v47, s[12:15], s40 offen offset:3072 sc1
    buffer_load_dwordx4 v[84:87], v3, s[12:15], s40 offen offset:0 sc1
    buffer_load_dwordx4 v[88:91], v3, s[12:15], s40 offen offset:1024 sc1
    buffer_load_dwordx4 v[92:95], v3, s[12:15], s40 offen offset:2048 sc1
    buffer_load_dwordx4 v[96:99], v3, s[12:15], s40 offen offset:3072 sc1
    s_waitcnt vmcnt(0)
    s_mov_b32 s42, 0
    v_xor_b32 v15, s3, v71
    v_xor_b32 v7, s3, v75
    v_or_b32 v15, v15, v7
    v_cmp_ne_u32 vcc, 0, v15
    s_nop 3
    s_cmp_lg_u64 vcc, 0
    s_cselect_b32 s43, 1, 0
    s_or_b32 s42, s42, s43
    v_xor_b32 v15, s3, v79
    v_xor_b32 v7, s3, v83
    v_or_b32 v15, v15, v7
    v_cmp_ne_u32 vcc, 0, v15
    s_nop 3
    s_cmp_lg_u64 vcc, 0
    s_cselect_b32 s43, 2, 0
    s_or_b32 s42, s42, s43
    v_xor_b32 v15, s3, v87
    v_xor_b32 v7, s3, v91
    v_or_b32 v15, v15, v7
    v_cmp_ne_u32 vcc, 0, v15
    s_nop 3
    s_cmp_lg_u64 vcc, 0
    s_cselect_b32 s43, 4, 0
    s_or_b32 s42, s42, s43
    v_xor_b32 v15, s3, v95
    v_xor_b32 v7, s3, v99
    v_or_b32 v15, v15, v7
    v_cmp_ne_u32 vcc, 0, v15
    s_nop 3
    s_cmp_lg_u64 vcc, 0
    s_cselect_b32 s43, 8, 0
    s_or_b32 s42, s42, s43
    s_cmp_eq_u32 s42, 0
    s_cbranch_scc1 k2_oproj
    s_mov_b32 vcc_lo, s42
    s_cmp_lt_u32 s41, 400
    s_cbranch_scc1 k2_poll
k2_miss:
    s_ff1_i32_b32 s42, vcc_lo
    s_lshl_b32 s43, s64, 2
    s_add_u32 s42, s42, s43
    s_add_u32 s42, s42, 1
    v_mov_b32 v7, 147460
    v_mov_b32 v15, s42
    ds_write_b32 v7, v15
k2_oproj:
    s_lshl_b32 s41, s64, 12
    v_add_u32 v2, s41, v47
    s_lshl_b32 s41, s64, 10
    s_add_u32 s41, s41, 32768
    v_add_u32 v3, s41, v47
    v_mov_b32 v71, v74
    ds_write_b128 v2, v[68:71] offset:0
    v_mov_b32 v79, v82
    ds_write_b128 v2, v[76:79] offset:1024
    v_mov_b32 v87, v90
    ds_write_b128 v2, v[84:87] offset:2048
    v_mov_b32 v95, v98
    ds_write_b128 v2, v[92:95] offset:3072
    s_mov_b32 exec_hi, 0
    ds_write_b64 v3, v[72:73] offset:0
    ds_write_b64 v3, v[80:81] offset:8
    ds_write_b64 v3, v[88:89] offset:512
    ds_write_b64 v3, v[96:97] offset:520
    s_mov_b64 exec, -1
    s_mul_i32 s41, s66, 20480
    s_mul_i32 s42, s64, 12288
    s_add_u32 s42, s42, 49152
    v_add_u32 v20, s42, v8
    v_add_u32 v24, s41, v8
    v_add_u32 v21, s42, v9
    v_add_u32 v25, s41, v9
    v_add_u32 v22, s42, v10
    v_add_u32 v26, s41, v10
    v_add_u32 v23, s42, v11
    v_add_u32 v27, s41, v11
    ds_read_b128 v[100:103], v20 offset:0
    ds_read_b128 v[104:107], v21 offset:0
    ds_read_b128 v[108:111], v22 offset:0
    ds_read_b128 v[112:115], v23 offset:0
    ds_read_b128 v[116:119], v20 offset:4096
    ds_read_b128 v[120:123], v21 offset:4096
    s_waitcnt lgkmcnt(0)
    s_barrier
    v_mov_b32 v7, 147460
    ds_read_b32 v15, v7
    ds_read_b128 v[68:71], v24 offset:0
    ds_read_b128 v[72:75], v25 offset:0
    ds_read_b128 v[76:79], v26 offset:0
    ds_read_b128 v[80:83], v27 offset:0
    ds_read_b128 v[84:87], v24 offset:4096
    ds_read_b128 v[88:91], v25 offset:4096
    s_waitcnt lgkmcnt(6)
    v_readfirstlane_b32 s43, v15
    s_nop 3
    s_cmp_eq_u32 s43, 0
    s_cbranch_scc1 k2_mm
    s_sub_u32 s34, s43, 1
    s_waitcnt vmcnt(0) lgkmcnt(0)
    s_barrier
    s_branch k2_restart
k2_mm:
    s_waitcnt lgkmcnt(5)
    v_mfma_f32_32x32x16_bf16 v[176:191], v[100:103], v[68:71], v[176:191]
    v_mfma_f32_32x32x16_bf16 v[192:207], v[48:51], v[68:71], v[192:207]
    ds_read_b128 v[92:95], v26 offset:4096
    ds_read_b128 v[124:127], v22 offset:4096
    s_waitcnt lgkmcnt(6)
    v_mfma_f32_32x32x16_bf16 v[176:191], v[104:107], v[72:75], v[176:191]
    ds_read_b128 v[96:99], v27 offset:4096
    ds_read_b128 v[128:131], v23 offset:4096
    s_waitcnt lgkmcnt(7)
    v_mfma_f32_32x32x16_bf16 v[176:191], v[108:111], v[76:79], v[176:191]
    ds_read_b128 v[68:71], v24 offset:8192
    ds_read_b128 v[100:103], v20 offset:8192
    s_waitcnt lgkmcnt(8)
    v_mfma_f32_32x32x16_bf16 v[176:191], v[112:115], v[80:83], v[176:191]
    ds_read_b128 v[72:75], v25 offset:8192
    ds_read_b128 v[104:107], v21 offset:8192
    s_waitcnt lgkmcnt(9)
    v_mfma_f32_32x32x16_bf16 v[176:191], v[116:119], v[84:87], v[176:191]
    v_mfma_f32_32x32x16_bf16 v[192:207], v[52:55], v[84:87], v[192:207]
    ds_read_b128 v[76:79], v26 offset:8192
    ds_read_b128 v[108:111], v22 offset:8192
    s_waitcnt lgkmcnt(10)
    v_mfma_f32_32x32x16_bf16 v[176:191], v[120:123], v[88:91], v[176:191]
    ds_read_b128 v[80:83], v27 offset:8192
    ds_read_b128 v[112:115], v23 offset:8192
    s_waitcnt lgkmcnt(10)
    v_mfma_f32_32x32x16_bf16 v[176:191], v[124:127], v[92:95], v[176:191]
    ds_read_b128 v[84:87], v24 offset:12288
    s_waitcnt lgkmcnt(9)
    v_mfma_f32_32x32x16_bf16 v[176:191], v[128:131], v[96:99], v[176:191]
    ds_read_b128 v[88:91], v25 offset:12288
    s_waitcnt lgkmcnt(8)
    v_mfma_f32_32x32x16_bf16 v[176:191], v[100:103], v[68:71], v[176:191]
    v_mfma_f32_32x32x16_bf16 v[192:207], v[56:59], v[68:71], v[192:207]
    ds_read_b128 v[92:95], v26 offset:12288
    s_waitcnt lgkmcnt(7)
    v_mfma_f32_32x32x16_bf16 v[176:191], v[104:107], v[72:75], v[176:191]
    ds_read_b128 v[96:99], v27 offset:12288
    s_waitcnt lgkmcnt(6)
    v_mfma_f32_32x32x16_bf16 v[176:191], v[108:111], v[76:79], v[176:191]
    ds_read_b128 v[68:71], v24 offset:16384
    s_waitcnt lgkmcnt(5)
    v_mfma_f32_32x32x16_bf16 v[176:191], v[112:115], v[80:83], v[176:191]
    ds_read_b128 v[72:75], v25 offset:16384
    s_waitcnt lgkmcnt(5)
    v_mfma_f32_32x32x16_bf16 v[176:191], v[212:215], v[84:87], v[176:191]
    v_mfma_f32_32x32x16_bf16 v[192:207], v[60:63], v[84:87], v[192:207]
    ds_read_b128 v[76:79], v26 offset:16384
    s_waitcnt lgkmcnt(5)
    v_mfma_f32_32x32x16_bf16 v[176:191], v[220:223], v[88:91], v[176:191]
    ds_read_b128 v[80:83], v27 offset:16384
    s_waitcnt lgkmcnt(5)
    v_mfma_f32_32x32x16_bf16 v[176:191], v[228:231], v[92:95], v[176:191]
    s_waitcnt lgkmcnt(4)
    v_mfma_f32_32x32x16_bf16 v[176:191], v[248:251], v[96:99], v[176:191]
    s_waitcnt lgkmcnt(3)
    v_mfma_f32_32x32x16_bf16 v[176:191], v[208:211], v[68:71], v[176:191]
    v_mfma_f32_32x32x16_bf16 v[192:207], v[64:67], v[68:71], v[192:207]
    s_waitcnt lgkmcnt(2)
    v_mfma_f32_32x32x16_bf16 v[176:191], v[216:219], v[72:75], v[176:191]
    s_waitcnt lgkmcnt(1)
    v_mfma_f32_32x32x16_bf16 v[176:191], v[224:227], v[76:79], v[176:191]
    s_waitcnt lgkmcnt(0)
    v_mfma_f32_32x32x16_bf16 v[176:191], v[252:255], v[80:83], v[176:191]
    v_add_u32 v2, s42, v47
    v_lshrrev_b32 v7, 4, v0
    v_bfe_u32 v15, v0, 2, 2
    v_mul_u32_u24 v15, 12288, v15
    v_lshl_add_u32 v7, v7, 4, v15
    v_and_b32 v15, 3, v0
    v_mul_u32_u24 v15, 1040, v15
    v_add_u32 v7, v7, v15
    v_add_u32 v7, 49152, v7
    ds_write_b128 v2, v[192:195] offset:4160
    ds_write_b128 v2, v[196:199] offset:5200
    ds_write_b128 v2, v[200:203] offset:6240
    ds_write_b128 v2, v[204:207] offset:7280
    v_lshrrev_b32 v15, 3, v0
    v_and_b32 v44, 1, v0
    v_lshl_add_u32 v15, v44, 5, v15
    v_bfe_u32 v44, v0, 1, 2
    v_mul_u32_u24 v44, 1040, v44
    v_lshl_add_u32 v15, v15, 4, v44
    v_add_u32 v15, 53312, v15
    v_add_u32 v44, 49152, v15
    ds_write_b128 v2, v[176:179] offset:0
    ds_write_b128 v2, v[180:183] offset:1040
    ds_write_b128 v2, v[184:187] offset:2080
    ds_write_b128 v2, v[188:191] offset:3120
    s_mov_b32 s16, s78
    s_mov_b32 s17, s79
    s_mov_b32 s18, 0x280000
    s_mov_b32 s19, 0x00020000
    s_waitcnt lgkmcnt(0)
    s_barrier
    ds_read_b128 v[68:71], v7 offset:0
    ds_read_b128 v[72:75], v7 offset:512
    ds_read_b128 v[76:79], v7 offset:49152
    ds_read_b128 v[80:83], v7 offset:49664
    s_cmp_ge_u32 s64, 4
    s_cbranch_scc1 k2_no5
    ds_read_b128 v[84:87], v15 offset:0
    ds_read_b128 v[88:91], v15 offset:12288
    ds_read_b128 v[92:95], v15 offset:24576
    ds_read_b128 v[96:99], v15 offset:36864
    ds_read_b128 v[100:103], v44 offset:0
    ds_read_b128 v[104:107], v44 offset:12288
    ds_read_b128 v[108:111], v44 offset:24576
    ds_read_b128 v[112:115], v44 offset:36864
k2_no5:
    v_lshlrev_b32 v120, 16, v28
    v_and_b32 v121, 0xffff0000, v28
    v_lshlrev_b32 v128, 16, v36
    v_and_b32 v129, 0xffff0000, v36
    v_lshlrev_b32 v122, 16, v29
    v_and_b32 v123, 0xffff0000, v29
    v_lshlrev_b32 v130, 16, v37
    v_and_b32 v131, 0xffff0000, v37
    v_lshlrev_b32 v124, 16, v30
    v_and_b32 v125, 0xffff0000, v30
    v_lshlrev_b32 v132, 16, v38
    v_and_b32 v133, 0xffff0000, v38
    v_lshlrev_b32 v126, 16, v31
    v_and_b32 v127, 0xffff0000, v31
    v_lshlrev_b32 v134, 16, v39
    v_and_b32 v135, 0xffff0000, v39
    v_pk_add_f32 v[120:121], v[120:121], v[128:129]
    v_pk_add_f32 v[122:123], v[122:123], v[130:131]
    v_pk_add_f32 v[124:125], v[124:125], v[132:133]
    v_pk_add_f32 v[126:127], v[126:127], v[134:135]
    v_lshlrev_b32 v136, 16, v32
    v_and_b32 v137, 0xffff0000, v32
    v_lshlrev_b32 v140, 16, v40
    v_and_b32 v141, 0xffff0000, v40
    v_lshlrev_b32 v138, 16, v33
    v_and_b32 v139, 0xffff0000, v33
    v_lshlrev_b32 v142, 16, v41
    v_and_b32 v143, 0xffff0000, v41
    v_pk_add_f32 v[136:137], v[136:137], v[140:141]
    v_pk_add_f32 v[138:139], v[138:139], v[142:143]
    s_waitcnt lgkmcnt(0)
    v_pk_add_f32 v[68:69], v[68:69], v[76:77]
    v_pk_add_f32 v[68:69], v[68:69], v[120:121]
    v_pk_add_f32 v[70:71], v[70:71], v[78:79]
    v_pk_add_f32 v[70:71], v[70:71], v[122:123]
    v_pk_add_f32 v[72:73], v[72:73], v[80:81]
    v_pk_add_f32 v[72:73], v[72:73], v[124:125]
    v_pk_add_f32 v[74:75], v[74:75], v[82:83]
    v_pk_add_f32 v[74:75], v[74:75], v[126:127]
    v_cvt_pk_bf16_f32 v76, v68, v69
    v_cvt_pk_bf16_f32 v77, v70, v71
    v_cvt_pk_bf16_f32 v78, v72, v73
    v_cvt_pk_bf16_f32 v79, v74, v75
    buffer_store_dwordx4 v[76:79], v13, s[16:19], 0 offen
    s_cmp_ge_u32 s64, 4
    s_cbranch_scc1 k2_fin
    v_pk_add_f32 v[136:137], v[136:137], v[84:85]
    v_pk_add_f32 v[138:139], v[138:139], v[86:87]
    v_pk_add_f32 v[136:137], v[136:137], v[88:89]
    v_pk_add_f32 v[138:139], v[138:139], v[90:91]
    v_pk_add_f32 v[136:137], v[136:137], v[92:93]
    v_pk_add_f32 v[138:139], v[138:139], v[94:95]
    v_pk_add_f32 v[136:137], v[136:137], v[96:97]
    v_pk_add_f32 v[138:139], v[138:139], v[98:99]
    v_pk_add_f32 v[136:137], v[136:137], v[100:101]
    v_pk_add_f32 v[138:139], v[138:139], v[102:103]
    v_pk_add_f32 v[136:137], v[136:137], v[104:105]
    v_pk_add_f32 v[138:139], v[138:139], v[106:107]
    v_pk_add_f32 v[136:137], v[136:137], v[108:109]
    v_pk_add_f32 v[138:139], v[138:139], v[110:111]
    v_pk_add_f32 v[136:137], v[136:137], v[112:113]
    v_pk_add_f32 v[138:139], v[138:139], v[114:115]
    v_cvt_pk_bf16_f32 v120, v136, v137
    v_cvt_pk_bf16_f32 v121, v138, v139
    buffer_store_dwordx2 v[120:121], v14, s[16:19], 0 offen
k2_fin:
k2_done:
    s_endpgm
k2_early:
    buffer_load_dwordx4 v[48:51], v8, s[72:75], s59 offen
    s_add_u32 s59, s59, 4096
    buffer_load_dwordx4 v[52:55], v8, s[72:75], s59 offen
    s_add_u32 s59, s59, 4096
    buffer_load_dwordx4 v[56:59], v8, s[72:75], s59 offen
    s_add_u32 s59, s59, 4096
    buffer_load_dwordx4 v[60:63], v8, s[72:75], s59 offen
    s_add_u32 s59, s59, 4096
    buffer_load_dwordx4 v[64:67], v8, s[72:75], s59 offen
    buffer_load_dwordx4 v[248:251], v11, s[72:75], s62 offen
    s_add_u32 s62, s62, 4096
    buffer_load_dwordx4 v[252:255], v11, s[72:75], s62 offen
    buffer_load_dwordx4 v[28:31], v13, s[8:11], 0 offen
    buffer_load_dwordx2 v[32:33], v14, s[8:11], 0 offen
    buffer_load_dwordx4 v[36:39], v42, s[16:19], 0 offen
    buffer_load_dwordx2 v[40:41], v43, s[16:19], 0 offen
    s_branch k2_early_ret
k2_fallback:
    s_mul_i32 s46, s64, 3072
    s_mov_b32 s38, 1
    s_waitcnt vmcnt(0)
    v_mov_b32 v152, 0x3f803f80
    v_mov_b32 v153, 0x3f803f80
    v_mov_b32 v158, 0x3f803f80
    v_mov_b32 v159, 0x3f803f80
    v_mov_b32 v2, 0xff61b1e6
    v_mov_b32 v3, 0xff61b1e6
    s_mov_b32 exec_lo, 0
    v_mov_b32 v20, 0
    v_mov_b32 v26, 0
    s_mov_b64 exec, -1
    v_subrev_u32 v4, s57, v4
    v_subrev_u32 v5, s57, v5
    s_mov_b32 s22, s51
    s_mov_b32 s47, 0
    s_mov_b32 s39, 0
k2_maxloop:
    s_add_u32 m0, s46, 0
    s_nop 0
    buffer_load_dwordx4 v12, s[20:23], s47 offen offset:0 lds
    buffer_load_dwordx4 v34, s[20:23], s47 offen offset:1024 lds
    buffer_load_dwordx4 v35, s[20:23], s47 offen offset:2048 lds
    s_add_u32 s47, s47, s45
    s_waitcnt vmcnt(0)
    s_barrier
    s_mov_b32 s40, 0
k2_maxin:
    ds_read_b128 v[148:151], v4 offset:0
    s_mov_b32 exec_hi, 0
    ds_read_b64 v[152:153], v5 offset:0
    s_mov_b32 exec_hi, -1
    s_waitcnt lgkmcnt(0)
    v_mfma_f32_32x32x16_bf16 v[68:83], v[148:151], v[16:19], 0
    v_mfma_f32_32x32x8_bf16 v[68:83], v[152:153], v[20:21], v[68:83]
    v_mfma_f32_32x32x16_bf16 v[84:99], v[148:151], v[22:25], 0
    v_mfma_f32_32x32x8_bf16 v[84:99], v[152:153], v[26:27], v[84:99]
    v_add_u32 v4, 512, v4
    v_add_u32 v5, 512, v5
    s_nop 15
    v_max3_f32 v2, v2, v68, v69
    v_max3_f32 v2, v2, v70, v71
    v_max3_f32 v2, v2, v72, v73
    v_max3_f32 v2, v2, v74, v75
    v_max3_f32 v2, v2, v76, v77
    v_max3_f32 v2, v2, v78, v79
    v_max3_f32 v2, v2, v80, v81
    v_max3_f32 v2, v2, v82, v83
    v_max3_f32 v3, v3, v84, v85
    v_max3_f32 v3, v3, v86, v87
    v_max3_f32 v3, v3, v88, v89
    v_max3_f32 v3, v3, v90, v91
    v_max3_f32 v3, v3, v92, v93
    v_max3_f32 v3, v3, v94, v95
    v_max3_f32 v3, v3, v96, v97
    v_max3_f32 v3, v3, v98, v99
    s_add_u32 s40, s40, 1
    s_cmp_lt_u32 s40, 8
    s_cbranch_scc1 k2_maxin
    v_subrev_u32 v4, 4096, v4
    v_subrev_u32 v5, 4096, v5
    s_barrier
    s_add_u32 s39, s39, 1
    s_cmp_lt_u32 s39, 8
    s_cbranch_scc1 k2_maxloop
    v_add_u32 v4, s57, v4
    v_add_u32 v5, s57, v5
    v_mov_b32 v7, v2
    s_nop 1
    v_permlane32_swap_b32 v2, v7
    s_nop 1
    v_max_f32 v2, v2, v7
    v_cvt_pk_bf16_f32 v7, -v2, -v2
    v_lshlrev_b32 v7, 16, v7
    v_sub_f32 v7, -v2, v7
    s_mov_b32 exec_lo, 0
    v_cvt_pk_bf16_f32 v20, -v2, v7
    s_mov_b64 exec, -1
    v_mov_b32 v7, v3
    s_nop 1
    v_permlane32_swap_b32 v3, v7
    s_nop 1
    v_max_f32 v3, v3, v7
    v_cvt_pk_bf16_f32 v7, -v3, -v3
    v_lshlrev_b32 v7, 16, v7
    v_sub_f32 v7, -v3, v7
    s_mov_b32 exec_lo, 0
    v_cvt_pk_bf16_f32 v26, -v3, v7
    s_mov_b64 exec, -1
    s_branch k2_main
.section .rodata,"a"
.p2align 6
.amdhsa_kernel k1_kernel
  .amdhsa_next_free_vgpr 256
  .amdhsa_next_free_sgpr 102
  .amdhsa_accum_offset 256
  .amdhsa_group_segment_fixed_size 0
  .amdhsa_kernarg_size 88
  .amdhsa_user_sgpr_count 2
  .amdhsa_user_sgpr_kernarg_segment_ptr 1
  .amdhsa_system_sgpr_workgroup_id_x 1
.end_amdhsa_kernel
.section .rodata,"a"
.p2align 6
.amdhsa_kernel k2_kernel
  .amdhsa_next_free_vgpr 256
  .amdhsa_next_free_sgpr 102
  .amdhsa_accum_offset 256
  .amdhsa_group_segment_fixed_size 0
  .amdhsa_kernarg_size 88
  .amdhsa_user_sgpr_count 2
  .amdhsa_user_sgpr_kernarg_segment_ptr 1
  .amdhsa_system_sgpr_workgroup_id_x 1
.end_amdhsa_kernel
```
